```python
import torch

def _softmax(x, axis=-1):
    return torch.softmax(x, dim=axis)
def _gelu(x):
    return torch.nn.functional.gelu(x, approximate="tanh")
def _silu(x):
    return torch.nn.functional.silu(x)
def _sigmoid(x):
    return torch.sigmoid(x)
def _layernorm(x, axis=-1, eps=1e-5):
    m = x.mean(dim=axis, keepdim=True)
    v = x.var(dim=axis, keepdim=True, unbiased=False)
    return (x - m) / torch.sqrt(v + eps)
def _scatter_add(tgt, idx, src, axis=0):
    return tgt.clone().index_add_(axis, idx, src)
def _segment_sum(src, seg, n):
    out = torch.zeros((n,) + src.shape[1:], dtype=src.dtype)
    return out.index_add_(0, seg, src)
def _pad(x, pw):
    flat = tuple(v for pair in reversed(pw) for v in pair)
    return torch.nn.functional.pad(x, flat)

kernel_name = 'gated_mix__spectral_fnet__sliding_local_dilated__prompt'

def setup_inputs():

    _w = (lambda a: (lambda t: t.to(torch.bfloat16) if t.is_floating_point() else t)(torch.as_tensor(a)))
    def _A_setup():
        B, S, D = 1, 2048, 640
        ns = torch.arange(S)[:, None] * torch.arange(S)[None, :]
        nd = torch.arange(D)[:, None] * torch.arange(D)[None, :]
        Ws_re = torch.cos(-2.0 * torch.pi * ns / S).to(float)
        Ws_im = torch.sin(-2.0 * torch.pi * ns / S).to(float)
        Wd_re = torch.cos(-2.0 * torch.pi * nd / D).to(float)
        Wd_im = torch.sin(-2.0 * torch.pi * nd / D).to(float)
        return {
            "x": _w((lambda *s: torch.randn(*s, dtype=torch.bfloat16) * 0.05)(B, S, D)),
            "dft_seq_re": _w(Ws_re),
            "dft_seq_im": _w(Ws_im),
            "dft_hid_re": _w(Wd_re),
            "dft_hid_im": _w(Wd_im),
        }
    _A_in = _A_setup()

    def _B_setup():
        B, S, D = 1, 2048, 640
        return {
            "x": _w((lambda *s: torch.randn(*s, dtype=torch.bfloat16) * 0.05)(B, S, D)),
            "wqkv": _w((lambda *s: torch.randn(*s, dtype=torch.bfloat16) * 1.6)(D, 3 * D)),
            "wo": _w((lambda *s: torch.randn(*s, dtype=torch.bfloat16) * 0.2)(D, D)),
        }
    _B_in = _B_setup()

    return {
        "A_x": _A_in["x"],
        "A_dft_seq_re": _A_in["dft_seq_re"],
        "A_dft_seq_im": _A_in["dft_seq_im"],
        "A_dft_hid_re": _A_in["dft_hid_re"],
        "A_dft_hid_im": _A_in["dft_hid_im"],
        "B_x": _B_in["x"],
        "B_wqkv": _B_in["wqkv"],
        "B_wo": _B_in["wo"],
        "gate_w": _w((lambda *s: torch.randn(*s, dtype=torch.bfloat16) * 0.05)(640) * 16.0),
    }

def reference(A_x, A_dft_seq_re, A_dft_seq_im, A_dft_hid_re, A_dft_hid_im, B_x, B_wqkv, B_wo, gate_w):
    def _A_ref(x, dft_seq_re, dft_seq_im, dft_hid_re, dft_hid_im):
        a = torch.einsum("bsd,ed->bse", x, dft_hid_re)
        b = torch.einsum("bsd,ed->bse", x, dft_hid_im)
        y = torch.einsum("ts,bse->bte", dft_seq_re, a) - torch.einsum("ts,bse->bte", dft_seq_im, b)
        return y

    def _B_ref(x, wqkv, wo):
        B, S, D = x.shape
        H = 32; Dh = D // H
        W, dil = 8, 2
        qkv = (lambda x, *d: x.permute(*d))((x @ wqkv).reshape(B, S, 3, H, Dh), 2, 0, 3, 1, 4)
        q, k, v = qkv[0], qkv[1], qkv[2]
        scale = Dh ** -0.5
        pos = torch.arange(S)
        off = torch.arange(W) * dil
        idx = pos[:, None] - off[None, :]
        mask = idx >= 0
        idx_c = torch.where(mask, idx, 0).reshape(-1)
        kg = k[:, :, idx_c, :].reshape(B, H, S, W, Dh)
        vg = v[:, :, idx_c, :].reshape(B, H, S, W, Dh)
        logits = torch.einsum("bhsd,bhswd->bhsw", q, kg) * scale
        logits = torch.where(mask[None, None, :, :], logits, -1e9)
        attn = _softmax(logits, axis=-1)
        o = torch.einsum("bhsw,bhswd->bhsd", attn, vg)
        return (lambda x, *d: x.permute(*d))(o, 0, 2, 1, 3).reshape(B, S, D) @ wo

    x = A_x
    g = _sigmoid((x * gate_w).sum(-1, keepdims=True))
    a = _A_ref(x, A_dft_seq_re, A_dft_seq_im, A_dft_hid_re, A_dft_hid_im)
    b = _B_ref(x, B_wqkv, B_wo)
    return g * a + (1 - g) * b
```

```asm
; @launch grid=(256,1,1) block=(512,1,1) lds=163840
.amdgcn_target "amdgcn-amd-amdhsa--gfx950"
.text
.globl gated_mix__spectral_fnet__sliding_local_dilated__prompt_kernel
.p2align 8
.type gated_mix__spectral_fnet__sliding_local_dilated__prompt_kernel,@function
gated_mix__spectral_fnet__sliding_local_dilated__prompt_kernel:
    s_load_dwordx16 s[16:31], s[0:1], 0
    s_load_dwordx8 s[32:39], s[0:1], 64
    s_getpc_b64 s[4:5]
L_pc:
    s_bfe_u32 s6, s2, 0x20003
    s_lshl_b32 s6, s6, 7
    v_lshl_add_u32 v2, v0, 9, s6
    v_min_u32 v2, L_codeend-L_pc-4, v2
    global_load_dword v255, v2, s[4:5]
    v_lshrrev_b32 v1, 6, v0
    v_and_b32 v0, 63, v0
    v_readfirstlane_b32 s3, v1
    s_lshr_b32 s6, s2, 3
    s_and_b32 s4, s2, 1
    s_sub_u32 s6, s6, 8
    s_cmp_ge_u32 s6, 20
    s_cbranch_scc1 L_other
    s_lshr_b32 s12, s6, 2
    s_bitcmp1_b32 s2, 1
    s_cselect_b32 s7, 5, 0
    s_add_u32 s7, s7, s12
    s_and_b32 s9, s6, 3
    s_and_b32 s8, s2, 4
    s_add_u32 s8, s8, s9
    s_mov_b32 s10, s7
    s_mulk_i32 s10, 105
    s_min_u32 s10, s10, 912
    s_cmp_ge_u32 s3, 4
    s_cbranch_scc1 L_qc
    s_lshl2_add_u32 s66, s6, s3
    s_mul_i32 s66, s3, 20
    s_add_u32 s66, s66, s6
    s_cmp_ge_u32 s66, 48
    s_cbranch_scc1 L_nocpf
    s_mul_i32 s65, s66, 171
    s_lshr_b32 s65, s65, 12
    s_mul_i32 s67, s65, 24
    s_sub_u32 s66, s66, s67
    s_lshl_b32 s67, s66, 6
    v_add_u32 v30, s67, v0
    v_mul_u32_u24 v31, 20, v30
    v_subrev_u32 v30, 576, v30
    v_mul_u32_u24 v32, 13108, v30
    v_lshrrev_b32 v32, 16, v32
    v_mad_u32_u24 v30, v32, 5, v30
    s_bitcmp1_b32 s2, 1
    s_cselect_b32 s67, 1050, 0
    s_add_u32 s67, s67, s4
    s_lshl_b32 s67, s67, 3
    s_and_b32 s68, s2, 4
    s_movk_i32 s69, 1920
    s_mov_b32 s42, 2621440
    s_mov_b32 s46, 2457600
    s_mov_b32 s51, 0x20000
    s_cmp_lt_u32 s66, 9
    s_cselect_b64 vcc, -1, 0
    s_cselect_b32 s67, s67, s68
    s_mulk_i32 s67, 160
    s_cselect_b32 s68, 1, s69
    s_mul_i32 s68, s68, s65
    v_cndmask_b32 v30, v30, v31, vcc
    v_add_lshl_u32 v30, v30, s68, 7
    s_cselect_b32 s50, s42, s46
    s_waitcnt lgkmcnt(0)
    s_cselect_b64 s[48:49], s[16:17], s[28:29]
    buffer_load_dword v254, v30, s[48:51], s67 offen
L_nocpf:
    v_lshrrev_b32 v18, 3, v0
    v_mul_u32_u24 v18, 40832, v18
    s_lshl_b32 s11, s3, 1
    v_xor_b32 v19, s11, v0
    v_lshl_add_u32 v230, v19, 4, v18
    s_movk_i32 s13, 1664
    v_add_u32 v231, s13, v230
    v_xor_b32 v232, 16, v231
    v_add_u32 v232, s13, v232
    v_add_u32 v233, s13, v232
    v_mul_u32_u24 v18, 52, v0
    v_lshrrev_b32 v18, 9, v18
    v_mul_u32_u24 v18, 35, v18
    v_lshl_add_u32 v18, v18, 1, v0
    v_lshlrev_b32 v234, 4, v18
    s_movk_i32 s13, 6720
    v_add_u32 v235, s13, v234
    v_add_u32 v236, 28800, v234
    v_add_u32 v237, s13, v236
    s_lshl1_add_u32 s11, s11, s10
    s_lshl1_add_u32 s11, s11, s4
    s_mulk_i32 s11, 1280
    s_mul_i32 s13, s3, 384
    s_add_u32 s13, s13, s8
    s_mulk_i32 s13, 160
    s_mov_b32 s12, 0
    s_mov_b32 s14, s3
    s_mulk_i32 s14, 3584
    s_lshl_b32 s15, s3, 12
    s_addk_i32 s15, 14336
    s_add_u32 s62, s14, 135168
    s_bfm_b32 s76, 24, 0
    s_bfm_b32 s77, 28, 0
    s_mov_b32 s42, 2621440
    s_mov_b32 s43, 0x20000
    s_mov_b32 s46, 2457600
    s_mov_b32 s47, s43
    s_waitcnt lgkmcnt(0)
    s_mov_b64 s[40:41], s[16:17]
    s_mov_b64 s[44:45], s[28:29]
    s_add_u32 s20, s38, 6062080
    s_addc_u32 s21, s39, 0
    s_load_dwordx2 s[18:19], s[20:21], 0
    s_call_b64 s[60:61], L_p2setup1
    s_call_b64 s[60:61], L_p2setup2
    s_call_b64 s[60:61], L_p2setup3
    s_call_b64 s[60:61], L_p2setup4
    s_call_b64 s[60:61], L_issue_a
    s_call_b64 s[60:61], L_issue
    s_branch L_ql_main
L_issue:
    s_add_u32 m0, s14, s15
    s_mul_i32 s65, s12, 245760
    s_mov_b32 exec_hi, s77
    s_add_u32 s65, s65, s13
    s_addk_i32 m0, 3840
    s_addk_i32 s65, 15360
    buffer_load_dwordx4 v234, s[44:47], s65 offen offset:0 lds
    buffer_load_dwordx4 v235, s[44:47], s65 offen offset:960 lds
    buffer_load_dwordx4 v236, s[44:47], s65 offen offset:1920 lds
    buffer_load_dwordx4 v237, s[44:47], s65 offen offset:2880 lds
    s_add_u32 s12, s12, 1
    s_add_u32 s14, s14, 45056
    s_cmp_eq_u32 s14, s62
    s_cselect_b32 s64, 135168, 0
    s_sub_u32 s14, s14, s64
L_issue_a:
    s_mov_b32 m0, s14
    s_lshl_b32 s64, s12, 7
    s_mov_b32 exec_hi, s76
    s_add_u32 s64, s64, s11
    buffer_load_dwordx4 v230, s[40:43], s64 offen offset:0 lds
    buffer_load_dwordx4 v231, s[40:43], s64 offen offset:896 lds
    buffer_load_dwordx4 v232, s[40:43], s64 offen offset:1792 lds
    buffer_load_dwordx4 v233, s[40:43], s64 offen offset:2688 lds
L_a3:
    s_add_u32 m0, s14, s15
    s_mul_i32 s65, s12, 245760
    s_mov_b32 exec_hi, s77
    s_add_u32 s65, s65, s13
    buffer_load_dwordx4 v234, s[44:47], s65 offen offset:0 lds
    buffer_load_dwordx4 v235, s[44:47], s65 offen offset:960 lds
    buffer_load_dwordx4 v236, s[44:47], s65 offen offset:1920 lds
    buffer_load_dwordx4 v237, s[44:47], s65 offen offset:2880 lds
    s_mov_b32 exec_hi, -1
    s_setpc_b64 s[60:61]
L_other:
    s_cmp_ge_u32 s2, 256
    s_cbranch_scc1 L_exit
    s_cmp_lt_u32 s2, 64
    s_cselect_b32 s6, 0, 160
    s_sub_u32 s6, s2, s6
    s_lshr_b32 s7, s6, 3
    s_and_b32 s66, s3, 1
    s_lshl1_add_u32 s66, s7, s66
    s_lshl_b32 s67, s66, 6
    v_add_u32 v30, s67, v0
    v_mul_u32_u24_e64 v31, 20, v30
    v_subrev_u32 v30, 576, v30
    v_mul_u32_u24 v32, 13108, v30
    v_lshrrev_b32 v32, 16, v32
    v_mad_u32_u24 v30, v32, 5, v30
    s_bitcmp1_b32 s2, 1
    s_cselect_b32 s67, 1050, 0
    s_add_u32 s67, s67, s4
    s_lshl_b32 s67, s67, 3
    s_and_b32 s68, s2, 4
    s_mov_b32 s69, 245760
    s_mov_b32 s42, 2621440
    s_mov_b32 s43, 0x20000
    s_mov_b32 s51, s43
    s_cmp_lt_u32 s66, 9
    s_cselect_b64 vcc, -1, 0
    s_cselect_b32 s67, s67, s68
    s_mulk_i32 s67, 160
    s_cselect_b32 s68, 128, s69
    v_cndmask_b32 v30, v30, v31, vcc
    v_lshlrev_b32 v30, 7, v30
    v_mov_b32 v254, v30
    s_cselect_b32 s50, s42, 2457600
    s_waitcnt lgkmcnt(0)
    s_cselect_b64 s[48:49], s[16:17], s[28:29]
    s_lshr_b32 s69, s3, 1
    s_add_u32 s69, s69, 5
    s_mul_i32 s69, s69, s68
    s_add_u32 s69, s69, s67
    s_cmp_ge_u32 s3, 2
    s_cbranch_scc1 L_noph0
    s_add_u32 s67, s67, s68
    s_add_u32 s67, s67, s68
    buffer_load_dword v33, v30, s[48:51], s67 offen
    s_add_u32 s67, s67, s68
    buffer_load_dword v33, v30, s[48:51], s67 offen
    s_add_u32 s67, s67, s68
    buffer_load_dword v33, v30, s[48:51], s67 offen
    s_add_u32 s67, s67, s68
L_noph0:
    v_mov_b32 v16, 163008
    v_mov_b32 v17, 163008
    v_mov_b32 v1, 1
    v_mov_b32 v18, 0
    v_mov_b32 v19, 4
    v_mov_b32 v20, 0
    v_mov_b32 v21, 8
    ds_write_b128 v16, v[18:21]
    v_mov_b64 v[4:5], 0
    v_mov_b64_e64 v[6:7], 0
    ds_write_b128 v16, v[4:7] offset:16
    ds_write_b128 v16, v[4:7] offset:32
    s_and_b32 s8, s7, 1
    s_lshr_b32 s9, s7, 1
    s_sub_u32 s7, s7, 8
    s_cmp_lt_u32 s2, 64
    s_cselect_b32 s8, s8, 2
    s_cselect_b32 s7, s9, s7
    s_and_b32 s9, s2, 6
    s_lshl1_add_u32 s7, s9, s7
    v_lshrrev_b32 v8, 3, v0
    v_mul_u32_u24 v9, 81792, v8
    v_lshlrev_b32 v13, 4, v0
    v_add_u32 v2, v13, v9
    s_lshr_b32 s14, s3, 2
    s_xor_b32 s14, s14, s8
    s_and_b32 s14, s14, 1
    s_lshl1_add_u32 s9, s7, s14
    s_lshl1_add_u32 s62, s9, s4
    s_and_b32 s63, s3, 3
    s_lshl_b32 s10, s63, 9
    s_add_u32 s75, s62, s10
    s_mulk_i32 s75, 1280
    s_lshl2_add_u32 s15, s14, s63
    s_mulk_i32 s15, 5120
    s_mov_b32 m0, s15
    s_mov_b64 s[40:41], s[16:17]
    s_waitcnt lgkmcnt(0)
    s_barrier
    s_cmp_ge_u32 s3, 4
    s_cbranch_scc1 L_noxl
    s_mov_b64 s[56:57], s[32:33]
    s_mov_b32 s58, 0x500
    s_mov_b32 s59, 0x20000
    buffer_load_dwordx4 v13, s[56:59], 0 offen lds
    buffer_load_dwordx4 v13, s[56:59], 0 offen offset:1024 lds
    buffer_load_dwordx4 v[96:99], v2, s[40:43], s75 offen offset:0
    buffer_load_dwordx4 v[100:103], v2, s[40:43], s75 offen offset:640
    buffer_load_dwordx4 v[104:107], v2, s[40:43], s75 offen offset:128
    buffer_load_dwordx4 v[108:111], v2, s[40:43], s75 offen offset:768
    buffer_load_dwordx4 v[112:115], v2, s[40:43], s75 offen offset:256
    buffer_load_dwordx4 v[116:119], v2, s[40:43], s75 offen offset:896
    buffer_load_dwordx4 v[120:123], v2, s[40:43], s75 offen offset:384
    buffer_load_dwordx4 v[124:127], v2, s[40:43], s75 offen offset:1024
    buffer_load_dwordx4 v[128:131], v2, s[40:43], s75 offen offset:512
    buffer_load_dwordx4 v[132:135], v2, s[40:43], s75 offen offset:1152
L_noxl:
    v_and_b32 v10, 7, v0
    s_branch L_dft3
L_p2setup1:
    s_bfe_u32 s70, s2, 0x30003
    s_mul_i32 s71, s3, 5120
    s_lshr_b32 s74, s2, 6
    s_sub_u32 s74, s74, 1
    s_max_i32 s74, s74, 0
    s_mul_i32 s73, s70, 102400
    s_add_u32 s73, s73, s71
    s_add_u32 s73, s73, 6063104
    s_mul_i32 s70, s70, 160
    v_min_u32 v74, 23, v0
    v_lshlrev_b32 v74, 7, v74
    v_add_u32 v74, 12288, v74
    s_mov_b64 s[52:53], s[38:39]
    s_mov_b32 s54, 0x690400
    s_mov_b32 s55, 0x20000
    s_mov_b64 s[48:49], s[34:35]
    s_mov_b32 s50, 0x280000
    s_mov_b32 s51, 0x20000
    s_bfe_u32 s65, s2, 0x30003
    s_and_b32 s25, s2, 1
    s_and_b32 s68, s2, 6
    s_lshr_b32 s69, s2, 7
    s_add_u32 s68, s68, s69
    s_lshl_b32 s68, s68, 1
    s_add_u32 s25, s25, s68
    s_sub_u32 s68, 32, s25
    s_cmp_eq_u32 s25, 0
    s_cselect_b32 s68, 16, s68
    s_bitcmp1_b32 s2, 6
    s_cselect_b32 s25, s68, s25
    s_sub_u32 s68, 32, s25
    s_and_b32 s68, s68, 31
    s_sub_u32 s69, 7, s65
    s_cmp_ge_u32 s65, 4
    s_cselect_b32 s66, s68, s25
    s_cselect_b32 s67, s69, s65
    s_cselect_b32 s29, 1, 0
    s_mul_i32 s78, s66, 98304
    s_mul_i32 s67, s67, 320
    s_add_u32 s78, s78, s67
    s_mul_i32 s67, s3, 4608
    s_add_u32 s78, s78, s67
    s_add_u32 s78, s78, 2621440
    s_and_b32 s79, s2, 7
    s_lshl_b32 s79, s79, 15
    s_add_u32 s79, s79, 5799936
    v_mul_u32_u24 v18, 49, v0
    v_lshrrev_b32_e64 v18, 10, v18
    v_mul_u32_u24 v18, 1200, v18
    v_lshl_add_u32 v79, v0, 4, v18
    v_lshlrev_b32_e64 v80, 7, v0
    v_and_b32 v81, 3968, v80
    v_add_u32 v81, 8192, v81
    v_add_u32 v82, 16384, v80
    v_and_b32 v83, 1920, v80
    v_add_u32 v83, 24576, v83
    v_mov_b32 v250, 163008
    v_mov_b32 v251, 1
    s_setpc_b64 s[60:61]
L_p2setup2:
    v_and_b32 v18, 15, v0
    v_lshrrev_b32 v19, 4, v0
    v_lshrrev_b32 v20, 5, v0
    v_lshlrev_b32 v2, 4, v0
    v_add_u32 v16, 65536, v2
    v_mul_u32_u24 v21, 325120, v20
    v_add_u32 v3, v2, v21
    s_mov_b32 s23, 135168
    s_cmp_eq_u32 s3, 1
    s_cselect_b32 s23, 110592, s23
    s_cmp_eq_u32 s3, 2
    s_cselect_b32 s23, 45056, s23
    s_cmp_eq_u32 s3, 3
    s_cselect_b32 s23, 65536, s23
    v_mul_u32_u24 v21, 160, v18
    v_lshl_add_u32 v21, v19, 4, v21
    v_add_u32 v4, s23, v21
    v_mul_u32_u24 v21, 2400, v20
    v_add_u32 v5, v4, v21
    s_lshl_b32 s22, s25, 2
    s_add_u32 s22, s22, s3
    s_lshl_b32 s24, s22, 7
    s_add_u32 s24, s24, 5767168
    s_mul_i32 s22, s22, 2560
    v_and_b32 v13, 1, v18
    v_mul_u32_u24 v13, 16376, v13
    v_lshl_add_u32 v13, v18, 3, v13
    s_lshl_b32 s66, s3, 9
    s_add_u32 s66, s66, s25
    v_lshl_add_u32 v20, v18, 5, s66
    v_mul_u32_u24 v14, 1280, v20
    v_add_u32 v14, s70, v14
    v_lshl_add_u32 v15, v19, 3, v14
    v_and_b32 v21, 1, v19
    v_lshl_add_u32 v14, v21, 5, v14
    v_and_b32 v21, 2, v19
    v_lshl_add_u32 v14, v21, 3, v14
    v_cvt_f32_u32 v20, v20
    s_lshl_b32 s66, s29, 31
    v_xor_b32 v20, s66, v20
    v_lshrrev_b32_e64 v21, 5, v0
    v_bfe_u32 v22, v0, 4, 1
    v_lshl_add_u32 v21, v22, 1, v21
    v_cvt_f32_u32 v21, v21
    v_mul_f32 v21, v21, v20
    v_mul_f32 v21, 0x3b000000, v21
    s_setpc_b64 s[60:61]
L_p2setup3:
    v_fmamk_f32 v22, v20, 0x0, v21
    v_fmamk_f32 v23, v20, 0x3a800000, v21
    v_cos_f32 v24, v22
    v_sin_f32 v22, v22
    v_cos_f32 v25, v23
    v_sin_f32_e64 v23, v23
    v_cvt_pk_bf16_f32 v46, v24, v22
    v_cvt_pk_bf16_f32 v47, v25, v23
    v_fmamk_f32 v22, v20, 0x3a000000, v21
    v_fmamk_f32 v23, v20, 0x3ac00000, v21
    v_cos_f32 v24, v22
    v_sin_f32 v22, v22
    v_cos_f32 v25, v23
    v_sin_f32 v23, v23
    v_cvt_pk_bf16_f32 v48, v24, v22
    v_cvt_pk_bf16_f32 v49, v25, v23
    v_fmamk_f32 v22, v20, 0x3c000000, v21
    v_fmamk_f32 v23, v20, 0x3c100000, v21
    v_cos_f32 v24, v22
    v_sin_f32 v22, v22
    v_cos_f32 v25, v23
    v_sin_f32 v23, v23
    v_cvt_pk_bf16_f32 v50, v24, v22
    v_cvt_pk_bf16_f32 v51, v25, v23
    v_fmamk_f32 v22, v20, 0x3c080000, v21
    v_fmamk_f32 v23, v20, 0x3c180000, v21
    v_cos_f32 v24, v22
    v_sin_f32 v22, v22
    v_cos_f32 v25, v23
    v_sin_f32 v23, v23
    v_cvt_pk_bf16_f32 v52, v24, v22
    v_cvt_pk_bf16_f32 v53, v25, v23
    s_setpc_b64 s[60:61]
L_p2setup4:
    v_fmamk_f32 v22, v20, 0x3c800000, v21
    v_fmamk_f32 v23, v20, 0x3c880000, v21
    v_cos_f32 v24, v22
    v_sin_f32 v22, v22
    v_cos_f32 v25, v23
    v_sin_f32_e64 v23, v23
    v_cvt_pk_bf16_f32 v54, v24, v22
    v_cvt_pk_bf16_f32 v55, v25, v23
    v_fmamk_f32 v22, v20, 0x3c840000, v21
    v_fmamk_f32 v23, v20, 0x3c8c0000, v21
    v_cos_f32 v24, v22
    v_sin_f32 v22, v22
    v_cos_f32 v25, v23
    v_sin_f32 v23, v23
    v_cvt_pk_bf16_f32 v56, v24, v22
    v_cvt_pk_bf16_f32 v57, v25, v23
    v_fmamk_f32 v22, v20, 0x3cc00000, v21
    v_fmamk_f32 v23, v20, 0x3cc80000, v21
    v_cos_f32 v24, v22
    v_sin_f32 v22, v22
    v_cos_f32 v25, v23
    v_sin_f32 v23, v23
    v_cvt_pk_bf16_f32 v58, v24, v22
    v_cvt_pk_bf16_f32 v59, v25, v23
    v_fmamk_f32 v22, v20, 0x3cc40000, v21
    v_fmamk_f32 v23, v20, 0x3ccc0000, v21
    v_cos_f32 v24, v22
    v_sin_f32 v22, v22
    v_cos_f32 v25, v23
    v_sin_f32 v23, v23
    v_cvt_pk_bf16_f32 v60, v24, v22
    v_cvt_pk_bf16_f32 v61, v25, v23
    s_cmp_eq_u32 s29, 0
    s_cselect_b32 s66, 0, 80
    s_cselect_b32 s67, 1, -1
    s_cselect_b32 s68, 64, 0xffffffc0
    v_bfe_u32 v22, v0, 4, 1
    v_lshrrev_b32_e64 v21, 5, v0
    v_lshl_add_u32 v22, v22, 2, v21
    v_mul_u32_u24 v22, 672, v22
    v_add_u32 v22, 135168, v22
    v_mul_lo_u32 v20, v18, s67
    v_add_u32 v20, s66, v20
    v_and_b32 v21, 1, v20
    v_mul_u32_u24 v21, 1344, v21
    v_lshrrev_b32 v20, 1, v20
    v_lshl_add_u32 v20, v20, 3, v21
    v_add_u32 v8, v20, v22
    v_add_u32 v9, s68, v8
    v_add_u32 v10, s68, v9
    v_add_u32 v11, s68, v10
    v_add_u32 v12, s68, v11
    s_mov_b32 s27, s3
    s_mov_b32 s28, 20000
    s_setpc_b64 s[60:61]
L_ql_main:
    s_waitcnt vmcnt(8)
    s_barrier
    s_call_b64 s[60:61], L_issue
    s_waitcnt vmcnt(8)
    s_barrier
    s_call_b64 s[60:61], L_issue
    s_waitcnt vmcnt(8)
    s_barrier
    s_call_b64 s[60:61], L_issue
    s_waitcnt vmcnt(8)
    s_barrier
    s_call_b64 s[60:61], L_issue
    s_waitcnt vmcnt(8)
    s_barrier
    s_call_b64 s[60:61], L_issue
    s_waitcnt vmcnt(8)
    s_barrier
    s_call_b64 s[60:61], L_issue
    s_waitcnt vmcnt(8)
    s_barrier
    s_call_b64 s[60:61], L_issue
    s_waitcnt lgkmcnt(0)
    s_bitcmp0_b32 s2, 0
    s_cselect_b32 s26, s18, s19
    s_add_u32 s26, s26, 1
    s_waitcnt vmcnt(8)
    s_barrier
    s_call_b64 s[60:61], L_issue
    s_waitcnt vmcnt(8)
    s_barrier
    s_add_u32 m0, s14, s15
    s_mul_i32 s65, s12, 245760
    s_mov_b32 exec_hi, s77
    s_add_u32 s65, s65, s13
    s_addk_i32 m0, 3840
    s_addk_i32 s65, 15360
    buffer_load_dwordx4 v234, s[44:47], s65 offen offset:0 lds
    buffer_load_dwordx4 v235, s[44:47], s65 offen offset:960 lds
    buffer_load_dwordx4 v236, s[44:47], s65 offen offset:1920 lds
    buffer_load_dwordx4 v237, s[44:47], s65 offen offset:2880 lds
    s_mov_b32 exec_hi, -1
    s_cmp_lg_u32 s3, 0
    s_cbranch_scc1 L_nop0
    buffer_load_dwordx4 v[66:69], v74, s[52:55], s79 offen sc1
L_nop0:
    s_waitcnt vmcnt(0)
    s_cmp_lg_u32 s3, 0
    s_cbranch_scc1 L_e2ok_q
    s_mov_b32 s66, 400000
    s_waitcnt vmcnt(0)
L_e2_q:
    v_xor_b32 v66, s26, v66
    v_xor_b32 v67, s26, v67
    v_xor_b32 v68, s26, v68
    v_xor_b32 v69, s26, v69
    v_or3_b32 v66, v66, v67, v68
    v_or_b32 v66, v66, v69
    v_cmp_ne_u32 vcc, 0, v66
    s_cbranch_vccz L_e2ok_q
    s_sleep 6
    buffer_load_dwordx4 v[66:69], v74, s[52:55], s79 offen sc1
    s_waitcnt vmcnt(0)
    s_sub_u32 s66, s66, 1
    s_cmp_lg_u32 s66, 0
    s_cbranch_scc1 L_e2_q
L_e2ok_q:
    s_barrier
L_post9:
    s_setprio 3
    s_add_u32 m0, s71, 45056
    s_add_u32 s72, s73, 0
    buffer_load_dwordx4 v2, s[52:55], s72 offen offset:0 sc1 lds
    buffer_load_dwordx4 v2, s[52:55], s72 offen offset:1024 sc1 lds
    buffer_load_dwordx4 v2, s[52:55], s72 offen offset:2048 sc1 lds
    buffer_load_dwordx4 v2, s[52:55], s72 offen offset:3072 sc1 lds
    s_addk_i32 m0, 4096
    s_addk_i32 s72, 4096
    buffer_load_dwordx4 v2, s[52:55], s72 offen sc1 lds
    s_add_u32 m0, s71, 65536
    s_add_u32 s72, s73, 20480
    buffer_load_dwordx4 v2, s[52:55], s72 offen offset:0 sc1 lds
    buffer_load_dwordx4 v2, s[52:55], s72 offen offset:1024 sc1 lds
    buffer_load_dwordx4 v2, s[52:55], s72 offen offset:2048 sc1 lds
    buffer_load_dwordx4 v2, s[52:55], s72 offen offset:3072 sc1 lds
    s_addk_i32 m0, 4096
    s_addk_i32 s72, 4096
    buffer_load_dwordx4 v2, s[52:55], s72 offen sc1 lds
    s_add_u32 m0, s71, 90112
    s_add_u32 s72, s73, 40960
    buffer_load_dwordx4 v2, s[52:55], s72 offen offset:0 sc1 lds
    buffer_load_dwordx4 v2, s[52:55], s72 offen offset:1024 sc1 lds
    buffer_load_dwordx4 v2, s[52:55], s72 offen offset:2048 sc1 lds
    buffer_load_dwordx4 v2, s[52:55], s72 offen offset:3072 sc1 lds
    s_addk_i32 m0, 4096
    s_addk_i32 s72, 4096
    buffer_load_dwordx4 v2, s[52:55], s72 offen sc1 lds
    s_cmp_lg_u32 s3, 0
    s_cbranch_scc1 L_nop1
    buffer_load_dword v66, v80, s[52:55], s79 offen sc1
    buffer_load_dword v67, v81, s[52:55], s79 offen sc1
L_nop1:
    s_branch L_spin1_c
L_spin_c:
    s_sleep 2
L_spin1_c:
    ds_read_b32 v18, v250 offset:4
    s_waitcnt lgkmcnt(0)
    v_readfirstlane_b32 s64, v18
    s_nop 1
    s_cmp_ge_u32 s64, 4
    s_cbranch_scc0 L_spin_c
    s_add_u32 m0, s71, 0
    s_add_u32 s72, s73, 61440
    buffer_load_dwordx4 v2, s[52:55], s72 offen offset:0 sc1 lds
    buffer_load_dwordx4 v2, s[52:55], s72 offen offset:1024 sc1 lds
    buffer_load_dwordx4 v2, s[52:55], s72 offen offset:2048 sc1 lds
    buffer_load_dwordx4 v2, s[52:55], s72 offen offset:3072 sc1 lds
    s_addk_i32 m0, 4096
    s_addk_i32 s72, 4096
    buffer_load_dwordx4 v2, s[52:55], s72 offen sc1 lds
    s_add_u32 m0, s71, 20480
    s_add_u32 s72, s73, 81920
    buffer_load_dwordx4 v2, s[52:55], s72 offen offset:0 sc1 lds
    buffer_load_dwordx4 v2, s[52:55], s72 offen offset:1024 sc1 lds
    buffer_load_dwordx4 v2, s[52:55], s72 offen offset:2048 sc1 lds
    buffer_load_dwordx4 v2, s[52:55], s72 offen offset:3072 sc1 lds
    s_addk_i32 m0, 4096
    s_addk_i32 s72, 4096
    buffer_load_dwordx4 v2, s[52:55], s72 offen sc1 lds
    s_cmp_lg_u32 s3, 0
    s_cbranch_scc1 L_nop2
    s_waitcnt vmcnt(10)
    v_xor_b32 v66, s26, v66
    v_xor_b32 v67, s26, v67
    v_or_b32 v66, v66, v67
    v_cmp_ne_u32 vcc, 0, v66
    s_cbranch_vccnz L_nof1
    s_call_b64 s[60:61], L_setf
L_nof1:
    s_mov_b64 exec, 1
    ds_add_u32 v250, v251 offset:32
    s_mov_b64 exec, -1
L_nop2:
    s_branch L_spin1_d1
L_spin_d1:
    s_sleep 1
L_spin1_d1:
    ds_read_b32 v18, v250 offset:32
    s_waitcnt lgkmcnt(0)
    v_readfirstlane_b32 s64, v18
    s_nop 1
    s_cmp_ge_u32 s64, 1
    s_cbranch_scc0 L_spin_d1
    ds_read_b32 v18, v250 offset:16
    s_waitcnt lgkmcnt(0)
    v_readfirstlane_b32 s27, v18
    s_nop 1
    s_cmp_eq_u32 s27, 0
    s_cbranch_scc1 L_noz1
    s_call_b64 s[60:61], L_zissue
L_noz1:
    s_cmp_lg_u32 s27, 0
    s_cbranch_scc1 L_zdone
    s_cmp_lg_u32 s3, 0
    s_cbranch_scc1 L_nop3
    s_mov_b32 s66, 400000
    buffer_load_dword v66, v80, s[52:55], s79 offen sc1
    buffer_load_dword v67, v81, s[52:55], s79 offen sc1
L_poll_d:
    s_sleep 3
    buffer_load_dword v68, v80, s[52:55], s79 offen sc1
    buffer_load_dword v69, v81, s[52:55], s79 offen sc1
    s_waitcnt vmcnt(2)
    v_xor_b32 v66, s26, v66
    v_xor_b32 v67, s26, v67
    v_or_b32 v66, v66, v67
    v_cmp_ne_u32 vcc, 0, v66
    s_cbranch_vccz L_polled_d
    s_sleep 3
    buffer_load_dword v66, v80, s[52:55], s79 offen sc1
    buffer_load_dword v67, v81, s[52:55], s79 offen sc1
    s_waitcnt vmcnt(2)
    v_xor_b32 v68, s26, v68
    v_xor_b32 v69, s26, v69
    v_or_b32 v68, v68, v69
    v_cmp_ne_u32 vcc, 0, v68
    s_cbranch_vccz L_polled_d
    s_sub_u32 s66, s66, 1
    s_cmp_lg_u32 s66, 0
    s_cbranch_scc1 L_poll_d
L_polled_d:
    s_call_b64 s[60:61], L_setf
L_nop3:
    s_branch L_spin1_f
L_spin_f:
    s_sleep 1
L_spin1_f:
    ds_read_b32 v18, v250 offset:16
    s_waitcnt lgkmcnt(0)
    v_readfirstlane_b32 s64, v18
    s_nop 1
    s_cmp_ge_u32 s64, 1
    s_cbranch_scc0 L_spin_f
    s_call_b64 s[60:61], L_zissue
L_zdone:
    s_barrier
    s_waitcnt vmcnt(0)
    s_mov_b64 exec, 1
    ds_add_u32 v250, v251 offset:0
    s_mov_b64 exec, -1
    s_setprio 0
    s_branch L_spin1_a
L_spin_a:
    s_sleep 1
L_spin1_a:
    ds_read_b32 v18, v250 offset:0
    s_waitcnt lgkmcnt(0)
    v_readfirstlane_b32 s64, v18
    s_nop 1
    s_cmp_ge_u32 s64, 4
    s_cbranch_scc0 L_spin_a
    ds_read_b64 v[90:91], v8 offset:0
    ds_read_b64 v[92:93], v8 offset:336
    ds_read_b64 v[94:95], v9 offset:0
    ds_read_b64 v[96:97], v9 offset:336
    ds_read_b64 v[98:99], v10 offset:0
    ds_read_b64 v[100:101], v10 offset:336
    ds_read_b64 v[102:103], v11 offset:0
    ds_read_b64 v[104:105], v11 offset:336
    ds_read_b64 v[106:107], v12 offset:0
    ds_read_b64 v[108:109], v12 offset:336
    ds_read_b64 v[110:111], v8 offset:5376
    ds_read_b64 v[112:113], v8 offset:5712
    ds_read_b64 v[114:115], v9 offset:5376
    ds_read_b64 v[116:117], v9 offset:5712
    ds_read_b64 v[118:119], v10 offset:5376
    ds_read_b64 v[120:121], v10 offset:5712
    ds_read_b64 v[122:123], v11 offset:5376
    ds_read_b64 v[124:125], v11 offset:5712
    ds_read_b64 v[126:127], v12 offset:5376
    ds_read_b64 v[128:129], v12 offset:5712
    ds_read_b64 v[130:131], v8 offset:10752
    ds_read_b64 v[132:133], v8 offset:11088
    ds_read_b64 v[134:135], v9 offset:10752
    ds_read_b64 v[136:137], v9 offset:11088
    ds_read_b64 v[138:139], v10 offset:10752
    ds_read_b64 v[140:141], v10 offset:11088
    ds_read_b64 v[142:143], v11 offset:10752
    ds_read_b64 v[144:145], v11 offset:11088
    ds_read_b64 v[146:147], v12 offset:10752
    ds_read_b64 v[148:149], v12 offset:11088
    ds_read_b64 v[150:151], v8 offset:16128
    ds_read_b64 v[152:153], v8 offset:16464
    ds_read_b64 v[154:155], v9 offset:16128
    ds_read_b64 v[156:157], v9 offset:16464
    ds_read_b64 v[158:159], v10 offset:16128
    ds_read_b64 v[160:161], v10 offset:16464
    ds_read_b64 v[162:163], v11 offset:16128
    ds_read_b64 v[164:165], v11 offset:16464
    ds_read_b64 v[166:167], v12 offset:16128
    ds_read_b64 v[168:169], v12 offset:16464
    ds_read_b128 v[170:173], v16 offset:0
    ds_read_b128 v[174:177], v16 offset:1024
    ds_read_b128 v[178:181], v16 offset:2048
    ds_read_b128 v[182:185], v16 offset:3072
    ds_read_b128 v[186:189], v16 offset:4096
    s_cmp_lg_u32 s3, 1
    s_cbranch_scc1 L_noep
    s_branch L_spin1_o2
L_spin_o2:
    s_sleep 1
L_spin1_o2:
    ds_read_b32 v18, v250 offset:12
    s_waitcnt lgkmcnt(0)
    v_readfirstlane_b32 s64, v18
    s_nop 1
    s_cmp_ge_u32 s64, 5
    s_cbranch_scc0 L_spin_o2
    buffer_load_dword v66, v82, s[52:55], s79 offen sc1
    buffer_load_dword v67, v83, s[52:55], s79 offen sc1
L_noep:
    s_waitcnt lgkmcnt(5)
    v_mfma_f32_16x16x32_bf16 v[26:29], v[90:93], v[46:49], 0
    ds_read_b128 v[90:93], v2 offset:45056
    v_mfma_f32_16x16x32_bf16 v[30:33], v[94:97], v[46:49], 0
    ds_read_b128 v[94:97], v2 offset:46080
    v_mfma_f32_16x16x32_bf16 v[34:37], v[98:101], v[46:49], 0
    ds_read_b128 v[98:101], v2 offset:47104
    v_mfma_f32_16x16x32_bf16 v[38:41], v[102:105], v[46:49], 0
    ds_read_b128 v[102:105], v2 offset:48128
    v_mfma_f32_16x16x32_bf16 v[42:45], v[106:109], v[46:49], 0
    ds_read_b128 v[106:109], v2 offset:49152
    v_mfma_f32_16x16x32_bf16 v[26:29], v[110:113], v[50:53], v[26:29]
    ds_read_b128 v[110:113], v2 offset:50176
    v_mfma_f32_16x16x32_bf16 v[30:33], v[114:117], v[50:53], v[30:33]
    ds_read_b128 v[114:117], v2 offset:51200
    v_mfma_f32_16x16x32_bf16 v[34:37], v[118:121], v[50:53], v[34:37]
    ds_read_b128 v[118:121], v2 offset:52224
    v_mfma_f32_16x16x32_bf16 v[38:41], v[122:125], v[50:53], v[38:41]
    ds_read_b128 v[122:125], v2 offset:53248
    v_mfma_f32_16x16x32_bf16 v[42:45], v[126:129], v[50:53], v[42:45]
    ds_read_b128 v[126:129], v2 offset:54272
    v_mfma_f32_16x16x32_bf16 v[26:29], v[130:133], v[54:57], v[26:29]
    ds_read_b128 v[130:133], v2 offset:55296
    v_mfma_f32_16x16x32_bf16 v[30:33], v[134:137], v[54:57], v[30:33]
    ds_read_b128 v[134:137], v2 offset:56320
    v_mfma_f32_16x16x32_bf16 v[34:37], v[138:141], v[54:57], v[34:37]
    ds_read_b128 v[138:141], v2 offset:57344
    v_mfma_f32_16x16x32_bf16 v[38:41], v[142:145], v[54:57], v[38:41]
    ds_read_b128 v[142:145], v2 offset:58368
    v_mfma_f32_16x16x32_bf16 v[42:45], v[146:149], v[54:57], v[42:45]
    ds_read_b128 v[146:149], v2 offset:59392
    v_mfma_f32_16x16x32_bf16 v[26:29], v[150:153], v[58:61], v[26:29]
    ds_read_b128 v[150:153], v2 offset:60416
    v_mfma_f32_16x16x32_bf16 v[30:33], v[154:157], v[58:61], v[30:33]
    ds_read_b128 v[154:157], v2 offset:61440
    v_mfma_f32_16x16x32_bf16 v[34:37], v[158:161], v[58:61], v[34:37]
    ds_read_b128 v[158:161], v2 offset:62464
    v_mfma_f32_16x16x32_bf16 v[38:41], v[162:165], v[58:61], v[38:41]
    ds_read_b128 v[162:165], v2 offset:63488
    v_mfma_f32_16x16x32_bf16 v[42:45], v[166:169], v[58:61], v[42:45]
    ds_read_b128 v[166:169], v2 offset:64512
    ds_read_b128 v[190:193], v16 offset:5120
    ds_read_b128 v[194:197], v16 offset:6144
    ds_read_b128 v[198:201], v16 offset:7168
    ds_read_b128 v[202:205], v16 offset:8192
    ds_read_b128 v[206:209], v16 offset:9216
    ds_read_b128 v[210:213], v16 offset:10240
    ds_read_b128 v[214:217], v16 offset:11264
    ds_read_b128 v[218:221], v16 offset:12288
    ds_read_b128 v[222:225], v16 offset:13312
    ds_read_b128 v[226:229], v16 offset:14336
    ds_read_b128 v[230:233], v16 offset:15360
    ds_read_b128 v[234:237], v16 offset:16384
    ds_read_b128 v[238:241], v16 offset:17408
    ds_read_b128 v[242:245], v16 offset:18432
    ds_read_b128 v[246:249], v16 offset:19456
    v_mul_f32 v26, v26, v6
    v_mul_f32 v27, v27, v6
    v_mul_f32 v28, v28, v6
    v_mul_f32 v29, v29, v6
    v_mul_f32 v30, v30, v6
    v_mul_f32 v31, v31, v6
    v_mul_f32 v32, v32, v6
    v_mul_f32 v33, v33, v6
    v_mul_f32 v34, v34, v6
    v_mul_f32 v35, v35, v6
    v_mul_f32 v36, v36, v6
    v_mul_f32 v37, v37, v6
    v_mul_f32 v38, v38, v6
    v_mul_f32 v39, v39, v6
    v_mul_f32 v40, v40, v6
    v_mul_f32 v41, v41, v6
    v_mul_f32 v42, v42, v6
    v_mul_f32 v43, v43, v6
    v_mul_f32 v44, v44, v6
    v_mul_f32 v45, v45, v6
    v_sub_f32 v6, 1.0, v6
    s_waitcnt vmcnt(0) lgkmcnt(0)
    s_setprio 3
    s_cmp_lg_u32 s3, 1
    s_cbranch_scc1 L_b13
    s_waitcnt vmcnt(0)
    v_xor_b32 v66, s26, v66
    v_xor_b32 v67, s26, v67
    v_or_b32 v66, v66, v67
    v_cmp_ne_u32 vcc, 0, v66
    s_cbranch_vccz L_polled_q
    s_mov_b32 s66, 400000
    buffer_load_dword v66, v82, s[52:55], s79 offen sc1
    buffer_load_dword v67, v83, s[52:55], s79 offen sc1
L_poll_q:
    s_sleep 2
    buffer_load_dword v68, v82, s[52:55], s79 offen sc1
    buffer_load_dword v69, v83, s[52:55], s79 offen sc1
    s_waitcnt vmcnt(2)
    v_xor_b32 v66, s26, v66
    v_xor_b32 v67, s26, v67
    v_or_b32 v66, v66, v67
    v_cmp_ne_u32 vcc, 0, v66
    s_cbranch_vccz L_polled_q
    s_sleep 2
    buffer_load_dword v66, v82, s[52:55], s79 offen sc1
    buffer_load_dword v67, v83, s[52:55], s79 offen sc1
    s_waitcnt vmcnt(2)
    v_xor_b32 v68, s26, v68
    v_xor_b32 v69, s26, v69
    v_or_b32 v68, v68, v69
    v_cmp_ne_u32 vcc, 0, v68
    s_cbranch_vccz L_polled_q
    s_sub_u32 s66, s66, 1
    s_cmp_lg_u32 s66, 0
    s_cbranch_scc1 L_poll_q
L_polled_q:
    s_cmp_ge_u32 s2, 2
    s_cbranch_scc1 L_b13
    s_lshl_b32 s65, s2, 2
    s_add_u32 s65, s65, 6062080
    v_mov_b32 v18, s65
    v_mov_b32 v19, s26
    s_mov_b64 exec, 1
    buffer_store_dword v19, v18, s[52:55], 0 offen
    s_mov_b64 exec, -1
L_b13:
    s_barrier
    s_add_u32 m0, s23, 0
    s_add_u32 s64, s22, 0
    buffer_load_dwordx4 v2, s[52:55], s64 offen sc1 lds
    s_add_u32 m0, s23, 1024
    s_add_u32 s64, s22, 1024
    buffer_load_dwordx4 v2, s[52:55], s64 offen sc1 lds
    s_add_u32 m0, s23, 2048
    s_add_u32 s64, s22, 2048
    buffer_load_dwordx4 v3, s[52:55], s64 offen sc1 lds
    s_add_u32 m0, s23, 3072
    s_add_u32 s64, s22, 328192
    buffer_load_dwordx4 v2, s[52:55], s64 offen sc1 lds
    s_add_u32 m0, s23, 4096
    s_add_u32 s64, s22, 329216
    buffer_load_dwordx4 v2, s[52:55], s64 offen sc1 lds
    s_add_u32 m0, s23, 5120
    s_add_u32 s64, s22, 655360
    buffer_load_dwordx4 v2, s[52:55], s64 offen sc1 lds
    s_add_u32 m0, s23, 6144
    s_add_u32 s64, s22, 656384
    buffer_load_dwordx4 v2, s[52:55], s64 offen sc1 lds
    s_add_u32 m0, s23, 7168
    s_add_u32 s64, s22, 657408
    buffer_load_dwordx4 v3, s[52:55], s64 offen sc1 lds
    s_add_u32 m0, s23, 8192
    s_add_u32 s64, s22, 983552
    buffer_load_dwordx4 v2, s[52:55], s64 offen sc1 lds
    s_add_u32 m0, s23, 9216
    s_add_u32 s64, s22, 984576
    buffer_load_dwordx4 v2, s[52:55], s64 offen sc1 lds
    s_add_u32 m0, s23, 10240
    s_add_u32 s64, s22, 1310720
    buffer_load_dwordx4 v2, s[52:55], s64 offen sc1 lds
    s_add_u32 m0, s23, 11264
    s_add_u32 s64, s22, 1311744
    buffer_load_dwordx4 v2, s[52:55], s64 offen sc1 lds
    s_add_u32 m0, s23, 12288
    s_add_u32 s64, s22, 1312768
    buffer_load_dwordx4 v3, s[52:55], s64 offen sc1 lds
    s_waitcnt vmcnt(10)
    ds_read_b128 v[66:69], v4 offset:0
    ds_read_b128 v[70:73], v4 offset:64
    s_waitcnt vmcnt(8)
    ds_read_b128 v[74:77], v5 offset:128
    s_waitcnt lgkmcnt(2)
    v_cmp_eq_u32 vcc, -1, v69
    s_cbranch_vccnz L_retry0
L_back0:
    ds_read_b128 v[78:81], v4 offset:2592
    s_waitcnt lgkmcnt(2)
    v_mfma_f32_16x16x32_bf16 v[46:49], v[90:93], v[66:69], 0
    v_cmp_eq_u32 vcc, -1, v73
    v_mfma_f32_16x16x32_bf16 v[50:53], v[94:97], v[66:69], 0
    ds_read_b128 v[90:93], v16 offset:24576
    v_mfma_f32_16x16x32_bf16 v[54:57], v[98:101], v[66:69], 0
    ds_read_b128 v[94:97], v16 offset:25600
    s_add_u32 m0, s23, 13312
    s_add_u32 s64, s22, 1638912
    buffer_load_dwordx4 v2, s[52:55], s64 offen sc1 lds
    v_mfma_f32_16x16x32_bf16 v[58:61], v[102:105], v[66:69], 0
    ds_read_b128 v[98:101], v16 offset:26624
    v_mfma_f32_16x16x32_bf16 v[62:65], v[106:109], v[66:69], 0
    s_add_u32 m0, s23, 14336
    s_add_u32 s64, s22, 1639936
    buffer_load_dwordx4 v2, s[52:55], s64 offen sc1 lds
    s_cbranch_vccnz L_retry1
L_back1:
    ds_read_b128 v[82:85], v4 offset:2656
    s_waitcnt lgkmcnt(5)
    v_mfma_f32_16x16x32_bf16 v[46:49], v[110:113], v[70:73], v[46:49]
    v_cmp_eq_u32_e64 vcc, -1, v77
    v_mfma_f32_16x16x32_bf16 v[50:53], v[114:117], v[70:73], v[50:53]
    ds_read_b128 v[102:105], v16 offset:27648
    v_mfma_f32_16x16x32_bf16 v[54:57], v[118:121], v[70:73], v[54:57]
    ds_read_b128 v[106:109], v16 offset:28672
    s_add_u32 m0, s23, 15360
    s_add_u32 s64, s22, 1966080
    buffer_load_dwordx4 v2, s[52:55], s64 offen sc1 lds
    v_mfma_f32_16x16x32_bf16 v[58:61], v[122:125], v[70:73], v[58:61]
    ds_read_b128 v[110:113], v16 offset:29696
    v_mfma_f32_16x16x32_bf16 v[62:65], v[126:129], v[70:73], v[62:65]
    ds_read_b128 v[114:117], v16 offset:30720
    s_add_u32 m0, s23, 16384
    s_add_u32 s64, s22, 1967104
    buffer_load_dwordx4 v2, s[52:55], s64 offen sc1 lds
    s_cbranch_vccnz L_retry2
L_back2:
    s_waitcnt vmcnt(9)
    ds_read_b128 v[86:89], v4 offset:5120
    s_waitcnt lgkmcnt(9)
    v_mfma_f32_16x16x32_bf16 v[46:49], v[130:133], v[74:77], v[46:49]
    v_cmp_eq_u32 vcc, -1, v81
    v_mfma_f32_16x16x32_bf16 v[50:53], v[134:137], v[74:77], v[50:53]
    ds_read_b128 v[118:121], v16 offset:31744
    v_mfma_f32_16x16x32_bf16 v[54:57], v[138:141], v[74:77], v[54:57]
    ds_read_b128 v[122:125], v16 offset:32768
    s_add_u32 m0, s23, 17408
    s_add_u32 s64, s22, 1968128
    buffer_load_dwordx4 v3, s[52:55], s64 offen sc1 lds
    v_mfma_f32_16x16x32_bf16 v[58:61], v[142:145], v[74:77], v[58:61]
    ds_read_b128 v[126:129], v16 offset:33792
    v_mfma_f32_16x16x32_bf16 v[62:65], v[146:149], v[74:77], v[62:65]
    s_add_u32 m0, s23, 18432
    s_add_u32 s64, s22, 2294272
    buffer_load_dwordx4 v2, s[52:55], s64 offen sc1 lds
    s_cbranch_vccnz L_retry3
L_back3:
    ds_read_b128 v[66:69], v4 offset:5184
    s_waitcnt lgkmcnt(9)
    v_mfma_f32_16x16x32_bf16 v[46:49], v[150:153], v[78:81], v[46:49]
    v_cmp_eq_u32_e64 vcc, -1, v85
    v_mfma_f32_16x16x32_bf16 v[50:53], v[154:157], v[78:81], v[50:53]
    ds_read_b128 v[130:133], v16 offset:34816
    v_mfma_f32_16x16x32_bf16 v[54:57], v[158:161], v[78:81], v[54:57]
    ds_read_b128 v[134:137], v16 offset:35840
    s_add_u32 m0, s23, 19456
    s_add_u32 s64, s22, 2295296
    buffer_load_dwordx4 v2, s[52:55], s64 offen sc1 lds
    v_mfma_f32_16x16x32_bf16 v[58:61], v[162:165], v[78:81], v[58:61]
    ds_read_b128 v[138:141], v16 offset:36864
    v_mfma_f32_16x16x32_bf16 v[62:65], v[166:169], v[78:81], v[62:65]
    ds_read_b128 v[142:145], v16 offset:37888
    s_cbranch_vccnz L_retry4
L_back4:
    s_waitcnt vmcnt(10)
    ds_read_b128 v[70:73], v5 offset:5248
    s_waitcnt lgkmcnt(9)
    v_mfma_f32_16x16x32_bf16 v[46:49], v[170:173], v[82:85], v[46:49]
    v_cmp_eq_u32 vcc, -1, v89
    v_mfma_f32_16x16x32_bf16 v[50:53], v[174:177], v[82:85], v[50:53]
    ds_read_b128 v[146:149], v16 offset:38912
    v_mfma_f32_16x16x32_bf16 v[54:57], v[178:181], v[82:85], v[54:57]
    ds_read_b128 v[150:153], v16 offset:39936
    v_mfma_f32_16x16x32_bf16 v[58:61], v[182:185], v[82:85], v[58:61]
    ds_read_b128 v[154:157], v16 offset:40960
    v_mfma_f32_16x16x32_bf16 v[62:65], v[186:189], v[82:85], v[62:65]
    s_cbranch_vccnz L_retry5
L_back5:
    ds_read_b128 v[74:77], v4 offset:7712
    s_waitcnt lgkmcnt(9)
    v_mfma_f32_16x16x32_bf16 v[46:49], v[190:193], v[86:89], v[46:49]
    v_cmp_eq_u32_e64 vcc, -1, v69
    v_mfma_f32_16x16x32_bf16 v[50:53], v[194:197], v[86:89], v[50:53]
    ds_read_b128 v[158:161], v16 offset:41984
    v_mfma_f32_16x16x32_bf16 v[54:57], v[198:201], v[86:89], v[54:57]
    ds_read_b128 v[162:165], v16 offset:43008
    v_mfma_f32_16x16x32_bf16 v[58:61], v[202:205], v[86:89], v[58:61]
    ds_read_b128 v[166:169], v16 offset:44032
    v_mfma_f32_16x16x32_bf16 v[62:65], v[206:209], v[86:89], v[62:65]
    ds_read_b128 v[170:173], v2 offset:0
    s_cbranch_vccnz L_retry6
L_back6:
    ds_read_b128 v[78:81], v4 offset:7776
    s_waitcnt lgkmcnt(9)
    v_mfma_f32_16x16x32_bf16 v[46:49], v[210:213], v[66:69], v[46:49]
    v_cmp_eq_u32_e64 vcc, -1, v73
    v_mfma_f32_16x16x32_bf16 v[50:53], v[214:217], v[66:69], v[50:53]
    ds_read_b128 v[174:177], v2 offset:1024
    v_mfma_f32_16x16x32_bf16 v[54:57], v[218:221], v[66:69], v[54:57]
    ds_read_b128 v[178:181], v2 offset:2048
    v_mfma_f32_16x16x32_bf16 v[58:61], v[222:225], v[66:69], v[58:61]
    ds_read_b128 v[182:185], v2 offset:3072
    v_mfma_f32_16x16x32_bf16 v[62:65], v[226:229], v[66:69], v[62:65]
    s_cbranch_vccnz L_retry7
L_back7:
    s_waitcnt vmcnt(7)
    ds_read_b128 v[82:85], v4 offset:10240
    s_waitcnt lgkmcnt(9)
    v_mfma_f32_16x16x32_bf16 v[46:49], v[230:233], v[70:73], v[46:49]
    v_cmp_eq_u32 vcc, -1, v77
    v_mfma_f32_16x16x32_bf16 v[50:53], v[234:237], v[70:73], v[50:53]
    ds_read_b128 v[186:189], v2 offset:4096
    v_mfma_f32_16x16x32_bf16 v[54:57], v[238:241], v[70:73], v[54:57]
    ds_read_b128 v[190:193], v2 offset:5120
    v_mfma_f32_16x16x32_bf16 v[58:61], v[242:245], v[70:73], v[58:61]
    ds_read_b128 v[194:197], v2 offset:6144
    v_mfma_f32_16x16x32_bf16 v[62:65], v[246:249], v[70:73], v[62:65]
    ds_read_b128 v[198:201], v2 offset:7168
    s_cbranch_vccnz L_retry8
L_back8:
    ds_read_b128 v[86:89], v4 offset:10304
    s_waitcnt lgkmcnt(9)
    v_mfma_f32_16x16x32_bf16 v[46:49], v[90:93], v[74:77], v[46:49]
    v_cmp_eq_u32_e64 vcc, -1, v81
    v_mfma_f32_16x16x32_bf16 v[50:53], v[94:97], v[74:77], v[50:53]
    ds_read_b128 v[202:205], v2 offset:8192
    v_mfma_f32_16x16x32_bf16 v[54:57], v[98:101], v[74:77], v[54:57]
    ds_read_b128 v[206:209], v2 offset:9216
    v_mfma_f32_16x16x32_bf16 v[58:61], v[102:105], v[74:77], v[58:61]
    ds_read_b128 v[210:213], v2 offset:10240
    v_mfma_f32_16x16x32_bf16 v[62:65], v[106:109], v[74:77], v[62:65]
    s_cbranch_vccnz L_retry9
L_back9:
    s_waitcnt vmcnt(5)
    ds_read_b128 v[66:69], v5 offset:10368
    s_waitcnt lgkmcnt(9)
    v_mfma_f32_16x16x32_bf16 v[46:49], v[110:113], v[78:81], v[46:49]
    v_cmp_eq_u32 vcc, -1, v85
    v_mfma_f32_16x16x32_bf16 v[50:53], v[114:117], v[78:81], v[50:53]
    ds_read_b128 v[214:217], v2 offset:11264
    v_mfma_f32_16x16x32_bf16 v[54:57], v[118:121], v[78:81], v[54:57]
    ds_read_b128 v[218:221], v2 offset:12288
    v_mfma_f32_16x16x32_bf16 v[58:61], v[122:125], v[78:81], v[58:61]
    ds_read_b128 v[222:225], v2 offset:13312
    v_mfma_f32_16x16x32_bf16 v[62:65], v[126:129], v[78:81], v[62:65]
    ds_read_b128 v[226:229], v2 offset:14336
    s_cbranch_vccnz L_retry10
L_back10:
    ds_read_b128 v[70:73], v4 offset:12832
    s_waitcnt lgkmcnt(9)
    v_mfma_f32_16x16x32_bf16 v[46:49], v[130:133], v[82:85], v[46:49]
    v_cmp_eq_u32_e64 vcc, -1, v89
    v_mfma_f32_16x16x32_bf16 v[50:53], v[134:137], v[82:85], v[50:53]
    ds_read_b128 v[230:233], v2 offset:15360
    v_mfma_f32_16x16x32_bf16 v[54:57], v[138:141], v[82:85], v[54:57]
    ds_read_b128 v[234:237], v2 offset:16384
    v_mfma_f32_16x16x32_bf16 v[58:61], v[142:145], v[82:85], v[58:61]
    ds_read_b128 v[238:241], v2 offset:17408
    v_mfma_f32_16x16x32_bf16 v[62:65], v[146:149], v[82:85], v[62:65]
    s_cbranch_vccnz L_retry11
L_back11:
    ds_read_b128 v[74:77], v4 offset:12896
    s_waitcnt lgkmcnt(9)
    v_mfma_f32_16x16x32_bf16 v[46:49], v[150:153], v[86:89], v[46:49]
    v_cmp_eq_u32_e64 vcc, -1, v69
    v_mfma_f32_16x16x32_bf16 v[50:53], v[154:157], v[86:89], v[50:53]
    ds_read_b128 v[242:245], v2 offset:18432
    v_mfma_f32_16x16x32_bf16 v[54:57], v[158:161], v[86:89], v[54:57]
    ds_read_b128 v[246:249], v2 offset:19456
    v_mfma_f32_16x16x32_bf16 v[58:61], v[162:165], v[86:89], v[58:61]
    ds_read_b128 v[90:93], v2 offset:20480
    v_mfma_f32_16x16x32_bf16 v[62:65], v[166:169], v[86:89], v[62:65]
    ds_read_b128 v[94:97], v2 offset:21504
    s_cbranch_vccnz L_retry12
L_back12:
    s_waitcnt vmcnt(2)
    ds_read_b128 v[78:81], v4 offset:15360
    s_waitcnt lgkmcnt(9)
    v_mfma_f32_16x16x32_bf16 v[46:49], v[170:173], v[66:69], v[46:49]
    v_cmp_eq_u32 vcc, -1, v73
    v_mfma_f32_16x16x32_bf16 v[50:53], v[174:177], v[66:69], v[50:53]
    ds_read_b128 v[98:101], v2 offset:22528
    v_mfma_f32_16x16x32_bf16 v[54:57], v[178:181], v[66:69], v[54:57]
    ds_read_b128 v[102:105], v2 offset:23552
    v_mfma_f32_16x16x32_bf16 v[58:61], v[182:185], v[66:69], v[58:61]
    ds_read_b128 v[106:109], v2 offset:24576
    v_mfma_f32_16x16x32_bf16 v[62:65], v[186:189], v[66:69], v[62:65]
    s_cbranch_vccnz L_retry13
L_back13:
    ds_read_b128 v[82:85], v4 offset:15424
    s_waitcnt lgkmcnt(9)
    v_mfma_f32_16x16x32_bf16 v[46:49], v[190:193], v[70:73], v[46:49]
    v_cmp_eq_u32_e64 vcc, -1, v77
    v_mfma_f32_16x16x32_bf16 v[50:53], v[194:197], v[70:73], v[50:53]
    ds_read_b128 v[110:113], v2 offset:25600
    v_mfma_f32_16x16x32_bf16 v[54:57], v[198:201], v[70:73], v[54:57]
    ds_read_b128 v[114:117], v2 offset:26624
    v_mfma_f32_16x16x32_bf16 v[58:61], v[202:205], v[70:73], v[58:61]
    ds_read_b128 v[118:121], v2 offset:27648
    v_mfma_f32_16x16x32_bf16 v[62:65], v[206:209], v[70:73], v[62:65]
    ds_read_b128 v[122:125], v2 offset:28672
    s_cbranch_vccnz L_retry14
L_back14:
    s_waitcnt vmcnt(0)
    ds_read_b128 v[86:89], v5 offset:15488
    s_waitcnt lgkmcnt(9)
    v_mfma_f32_16x16x32_bf16 v[46:49], v[210:213], v[74:77], v[46:49]
    v_cmp_eq_u32 vcc, -1, v81
    v_mfma_f32_16x16x32_bf16 v[50:53], v[214:217], v[74:77], v[50:53]
    ds_read_b128 v[126:129], v2 offset:29696
    v_mfma_f32_16x16x32_bf16 v[54:57], v[218:221], v[74:77], v[54:57]
    ds_read_b128 v[130:133], v2 offset:30720
    v_mfma_f32_16x16x32_bf16 v[58:61], v[222:225], v[74:77], v[58:61]
    ds_read_b128 v[134:137], v2 offset:31744
    v_mfma_f32_16x16x32_bf16 v[62:65], v[226:229], v[74:77], v[62:65]
    s_cbranch_vccnz L_retry15
L_back15:
    ds_read_b128 v[66:69], v4 offset:17952
    s_waitcnt lgkmcnt(9)
    v_mfma_f32_16x16x32_bf16 v[46:49], v[230:233], v[78:81], v[46:49]
    v_cmp_eq_u32_e64 vcc, -1, v85
    v_mfma_f32_16x16x32_bf16 v[50:53], v[234:237], v[78:81], v[50:53]
    ds_read_b128 v[138:141], v2 offset:32768
    v_mfma_f32_16x16x32_bf16 v[54:57], v[238:241], v[78:81], v[54:57]
    ds_read_b128 v[142:145], v2 offset:33792
    v_mfma_f32_16x16x32_bf16 v[58:61], v[242:245], v[78:81], v[58:61]
    ds_read_b128 v[146:149], v2 offset:34816
    v_mfma_f32_16x16x32_bf16 v[62:65], v[246:249], v[78:81], v[62:65]
    ds_read_b128 v[150:153], v2 offset:35840
    s_cbranch_vccnz L_retry16
L_back16:
    ds_read_b128 v[70:73], v4 offset:18016
    s_waitcnt lgkmcnt(9)
    v_mfma_f32_16x16x32_bf16 v[46:49], v[90:93], v[82:85], v[46:49]
    v_cmp_eq_u32_e64 vcc, -1, v89
    v_mfma_f32_16x16x32_bf16 v[50:53], v[94:97], v[82:85], v[50:53]
    ds_read_b128 v[154:157], v2 offset:36864
    v_mfma_f32_16x16x32_bf16 v[54:57], v[98:101], v[82:85], v[54:57]
    ds_read_b128 v[158:161], v2 offset:37888
    v_mfma_f32_16x16x32_bf16 v[58:61], v[102:105], v[82:85], v[58:61]
    ds_read_b128 v[162:165], v2 offset:38912
    v_mfma_f32_16x16x32_bf16 v[62:65], v[106:109], v[82:85], v[62:65]
    s_cbranch_vccnz L_retry17
L_back17:
    s_waitcnt lgkmcnt(8)
    v_mfma_f32_16x16x32_bf16 v[46:49], v[110:113], v[86:89], v[46:49]
    v_cmp_eq_u32_e64 vcc, -1, v69
    v_mfma_f32_16x16x32_bf16 v[50:53], v[114:117], v[86:89], v[50:53]
    ds_read_b128 v[166:169], v2 offset:39936
    v_mfma_f32_16x16x32_bf16 v[54:57], v[118:121], v[86:89], v[54:57]
    v_mfma_f32_16x16x32_bf16 v[58:61], v[122:125], v[86:89], v[58:61]
    v_mfma_f32_16x16x32_bf16 v[62:65], v[126:129], v[86:89], v[62:65]
    s_cbranch_vccnz L_retry18
L_back18:
    s_waitcnt lgkmcnt(4)
    v_mfma_f32_16x16x32_bf16 v[46:49], v[130:133], v[66:69], v[46:49]
    v_cmp_eq_u32_e64 vcc, -1, v73
    v_mfma_f32_16x16x32_bf16 v[50:53], v[134:137], v[66:69], v[50:53]
    v_mfma_f32_16x16x32_bf16 v[54:57], v[138:141], v[66:69], v[54:57]
    v_mfma_f32_16x16x32_bf16 v[58:61], v[142:145], v[66:69], v[58:61]
    v_mfma_f32_16x16x32_bf16 v[62:65], v[146:149], v[66:69], v[62:65]
    s_cbranch_vccnz L_retry19
L_back19:
    s_waitcnt lgkmcnt(0)
    v_mfma_f32_16x16x32_bf16 v[46:49], v[150:153], v[70:73], v[46:49]
    v_mfma_f32_16x16x32_bf16 v[50:53], v[154:157], v[70:73], v[50:53]
    v_mfma_f32_16x16x32_bf16 v[54:57], v[158:161], v[70:73], v[54:57]
    v_mfma_f32_16x16x32_bf16 v[58:61], v[162:165], v[70:73], v[58:61]
    v_mfma_f32_16x16x32_bf16 v[62:65], v[166:169], v[70:73], v[62:65]
    s_nop 3
    v_fma_f32 v26, v46, v6, v26
    v_fma_f32 v27, v47, v6, v27
    v_fma_f32 v28, v48, v6, v28
    v_fma_f32 v29, v49, v6, v29
    v_cvt_pk_bf16_f32 v150, v26, v27
    v_cvt_pk_bf16_f32 v151, v28, v29
    v_fma_f32 v30, v50, v6, v30
    v_fma_f32 v31, v51, v6, v31
    v_fma_f32 v32, v52, v6, v32
    v_fma_f32 v33, v53, v6, v33
    v_cvt_pk_bf16_f32 v152, v30, v31
    v_cvt_pk_bf16_f32 v153, v32, v33
    v_fma_f32 v34, v54, v6, v34
    v_permlane16_swap_b32 v150, v152
    v_permlane16_swap_b32_e64 v151, v153
    buffer_store_dwordx4 v[150:153], v14, s[48:51], 0 offen offset:0
    v_fma_f32 v35, v55, v6, v35
    v_fma_f32 v36, v56, v6, v36
    v_fma_f32 v37, v57, v6, v37
    v_cvt_pk_bf16_f32 v154, v34, v35
    v_cvt_pk_bf16_f32 v155, v36, v37
    v_fma_f32 v38, v58, v6, v38
    v_fma_f32 v39, v59, v6, v39
    v_fma_f32 v40, v60, v6, v40
    v_fma_f32 v41, v61, v6, v41
    v_cvt_pk_bf16_f32 v156, v38, v39
    v_cvt_pk_bf16_f32 v157, v40, v41
    v_fma_f32 v42, v62, v6, v42
    v_permlane16_swap_b32 v154, v156
    v_permlane16_swap_b32 v155, v157
    buffer_store_dwordx4 v[154:157], v14, s[48:51], 0 offen offset:64
    v_fma_f32 v43, v63, v6, v43
    v_fma_f32 v44, v64, v6, v44
    v_fma_f32 v45, v65, v6, v45
    v_cvt_pk_bf16_f32 v158, v42, v43
    v_cvt_pk_bf16_f32 v159, v44, v45
    buffer_store_dwordx2 v[158:159], v15, s[48:51], 0 offen offset:128
    s_endpgm
L_setf:
    s_mov_b64 exec, 1
    ds_add_u32 v250, v251 offset:16
    ds_add_u32 v250, v251 offset:12
    s_mov_b64 exec, -1
    s_setpc_b64 s[60:61]
L_zissue:
    buffer_load_dword v6, v13, s[52:55], s24 offen sc1
    s_mul_i32 s64, s3, 1008
    s_add_u32 m0, s64, 135168
    s_mov_b32 exec_hi, 0x7fffffff
    buffer_load_dwordx4 v79, s[52:55], s78 offen sc1 lds
    s_add_u32 m0, m0, 4032
    s_add_u32 s78, s78, 18432
    buffer_load_dwordx4 v79, s[52:55], s78 offen sc1 lds
    s_add_u32 m0, m0, 4032
    s_add_u32 s78, s78, 18432
    buffer_load_dwordx4 v79, s[52:55], s78 offen sc1 lds
    s_add_u32 m0, m0, 4032
    s_add_u32 s78, s78, 18432
    buffer_load_dwordx4 v79, s[52:55], s78 offen sc1 lds
    s_add_u32 m0, m0, 4032
    s_add_u32 s78, s78, 18432
    buffer_load_dwordx4 v79, s[52:55], s78 offen sc1 lds
    s_add_u32 m0, m0, 4032
    s_add_u32 s78, s78, 18432
    s_cmp_ge_u32 s3, 2
    s_cbranch_scc1 L_zret
    buffer_load_dwordx4 v79, s[52:55], s78 offen sc1 lds
L_zret:
    s_mov_b32 exec_hi, -1
    s_setpc_b64 s[60:61]
L_odma0:
    s_add_u32 s64, s22, 0
    buffer_load_dwordx4 v2, s[52:55], s64 offen sc1 lds
    s_add_u32 m0, m0, 1024
    s_add_u32 s64, s22, 1024
    buffer_load_dwordx4 v2, s[52:55], s64 offen sc1 lds
    s_add_u32 m0, m0, 1024
    s_add_u32 s64, s22, 2048
    buffer_load_dwordx4 v3, s[52:55], s64 offen sc1 lds
    s_add_u32 m0, m0, 1024
    s_add_u32 s64, s22, 328192
    buffer_load_dwordx4 v2, s[52:55], s64 offen sc1 lds
    s_add_u32 m0, m0, 1024
    s_add_u32 s64, s22, 329216
    buffer_load_dwordx4 v2, s[52:55], s64 offen sc1 lds
    s_add_u32 m0, m0, 1024
L_odma1:
    s_add_u32 s64, s22, 655360
    buffer_load_dwordx4 v2, s[52:55], s64 offen sc1 lds
    s_add_u32 m0, m0, 1024
    s_add_u32 s64, s22, 656384
    buffer_load_dwordx4 v2, s[52:55], s64 offen sc1 lds
    s_add_u32 m0, m0, 1024
    s_add_u32 s64, s22, 657408
    buffer_load_dwordx4 v3, s[52:55], s64 offen sc1 lds
    s_add_u32 m0, m0, 1024
    s_add_u32 s64, s22, 983552
    buffer_load_dwordx4 v2, s[52:55], s64 offen sc1 lds
    s_add_u32 m0, m0, 1024
    s_add_u32 s64, s22, 984576
    buffer_load_dwordx4 v2, s[52:55], s64 offen sc1 lds
    s_add_u32 m0, m0, 1024
L_odma2:
    s_add_u32 s64, s22, 1310720
    buffer_load_dwordx4 v2, s[52:55], s64 offen sc1 lds
    s_add_u32 m0, m0, 1024
    s_add_u32 s64, s22, 1311744
    buffer_load_dwordx4 v2, s[52:55], s64 offen sc1 lds
    s_add_u32 m0, m0, 1024
    s_add_u32 s64, s22, 1312768
    buffer_load_dwordx4 v3, s[52:55], s64 offen sc1 lds
    s_add_u32 m0, m0, 1024
    s_add_u32 s64, s22, 1638912
    buffer_load_dwordx4 v2, s[52:55], s64 offen sc1 lds
    s_add_u32 m0, m0, 1024
    s_add_u32 s64, s22, 1639936
    buffer_load_dwordx4 v2, s[52:55], s64 offen sc1 lds
    s_add_u32 m0, m0, 1024
L_odma3:
    s_add_u32 s64, s22, 1966080
    buffer_load_dwordx4 v2, s[52:55], s64 offen sc1 lds
    s_add_u32 m0, m0, 1024
    s_add_u32 s64, s22, 1967104
    buffer_load_dwordx4 v2, s[52:55], s64 offen sc1 lds
    s_add_u32 m0, m0, 1024
    s_add_u32 s64, s22, 1968128
    buffer_load_dwordx4 v3, s[52:55], s64 offen sc1 lds
    s_add_u32 m0, m0, 1024
    s_add_u32 s64, s22, 2294272
    buffer_load_dwordx4 v2, s[52:55], s64 offen sc1 lds
    s_add_u32 m0, m0, 1024
    s_add_u32 s64, s22, 2295296
    buffer_load_dwordx4 v2, s[52:55], s64 offen sc1 lds
    s_add_u32 m0, m0, 1024
    s_setpc_b64 s[60:61]
L_qc:
    s_sub_u32 s9, s3, 4
    s_bfe_u32 s5, s2, 0x20001
    s_mul_i32 s12, s9, 40
    v_and_b32 v194, 15, v0
    v_lshrrev_b32 v195, 4, v0
    v_lshrrev_b32 v196, 1, v194
    v_xor_b32 v196, v196, v195
    v_lshlrev_b32 v196, 4, v196
    v_mul_u32_u24 v197, 896, v194
    v_add_u32 v2, v197, v196
    v_xor_b32 v3, 64, v2
    v_lshrrev_b32 v196, 5, v0
    v_bfe_u32 v197, v0, 2, 3
    v_lshl_add_u32 v196, v196, 4, v197
    v_mul_u32_u24 v196, 480, v196
    s_add_u32 s13, s12, 14336
    v_add_u32 v196, s13, v196
    v_and_b32 v197, 3, v0
    v_lshl_add_u32 v4, v197, 3, v196
    v_cmp_eq_u32 vcc, 1, v197
    v_min_u32 v197, 2, v197
    v_mul_u32_u24 v197, 160, v197
    v_add3_u32 v5, v196, v197, 32
    v_cndmask_b32_e64 v28, 0, 1.0, vcc
    v_cndmask_b32_e64 v29, 0, 1.0, vcc
    v_cndmask_b32_e64 v30, 0, 1.0, vcc
    v_cndmask_b32_e64 v31, 0, 1.0, vcc
    v_mov_b64 v[40:41], 0
    v_mov_b64 v[42:43], 0
    v_mov_b64 v[44:45], 0
    v_mov_b64 v[46:47], 0
    v_mov_b64 v[48:49], 0
    v_mov_b64 v[50:51], 0
    v_mov_b64 v[52:53], 0
    v_mov_b64 v[54:55], 0
    v_mov_b64 v[56:57], 0
    v_mov_b64 v[58:59], 0
    v_mov_b64 v[60:61], 0
    v_mov_b64 v[62:63], 0
    v_mov_b64 v[64:65], 0
    v_mov_b64 v[66:67], 0
    v_mov_b64 v[68:69], 0
    v_mov_b64 v[70:71], 0
    v_mov_b64 v[72:73], 0
    v_mov_b64 v[74:75], 0
    v_mov_b64 v[76:77], 0
    v_mov_b64 v[78:79], 0
    v_mov_b64 v[80:81], 0
    v_mov_b64 v[82:83], 0
    v_mov_b64 v[84:85], 0
    v_mov_b64 v[86:87], 0
    v_mov_b64 v[88:89], 0
    v_mov_b64 v[90:91], 0
    v_mov_b64 v[92:93], 0
    v_mov_b64 v[94:95], 0
    v_mov_b64 v[96:97], 0
    v_mov_b64 v[98:99], 0
    v_mov_b64 v[100:101], 0
    v_mov_b64 v[102:103], 0
    v_mov_b64 v[104:105], 0
    v_mov_b64 v[106:107], 0
    v_mov_b64 v[108:109], 0
    v_mov_b64 v[110:111], 0
    v_mov_b64 v[112:113], 0
    v_mov_b64 v[114:115], 0
    v_mov_b64 v[116:117], 0
    v_mov_b64 v[118:119], 0
    v_mov_b64 v[120:121], 0
    v_mov_b64 v[122:123], 0
    v_mov_b64 v[124:125], 0
    v_mov_b64 v[126:127], 0
    v_mov_b64 v[128:129], 0
    v_mov_b64 v[130:131], 0
    v_mov_b64 v[132:133], 0
    v_mov_b64 v[134:135], 0
    v_mov_b64 v[136:137], 0
    v_mov_b64 v[138:139], 0
    v_mov_b64 v[140:141], 0
    v_mov_b64 v[142:143], 0
    v_mov_b64 v[144:145], 0
    v_mov_b64 v[146:147], 0
    v_mov_b64 v[148:149], 0
    v_mov_b64 v[150:151], 0
    v_mov_b64 v[152:153], 0
    v_mov_b64 v[154:155], 0
    v_mov_b64 v[156:157], 0
    v_mov_b64 v[158:159], 0
    v_mov_b64 v[160:161], 0
    v_mov_b64 v[162:163], 0
    v_mov_b64 v[164:165], 0
    v_mov_b32 v36, 163008
    v_mov_b32 v37, 1
    ds_write_b128 v36, v[82:85]
    ds_write_b32 v36, v82 offset:16
    ds_write_b128 v36, v[82:85] offset:32
    v_lshlrev_b32 v196, 2, v195
    v_sub_u32 v196, v194, v196
    v_mov_b32 v198, 0xf149f2ca
    v_subrev_u32 v197, 0, v196
    v_cmp_gt_u32 vcc, 8, v197
    v_add_u32_e64 v197, 16, v196
    v_cmp_gt_u32 s[64:65], 8, v197
    v_cndmask_b32_e64 v10, v198, 0, vcc
    s_nop 0
    v_cndmask_b32_e64 v14, v198, 0, s[64:65]
    v_subrev_u32 v197, 1, v196
    v_cmp_gt_u32 vcc, 8, v197
    v_add_u32 v197, 15, v196
    v_cmp_gt_u32 s[64:65], 8, v197
    v_cndmask_b32_e64 v11, v198, 0, vcc
    s_nop 0
    v_cndmask_b32_e64 v15, v198, 0, s[64:65]
    v_subrev_u32 v197, 2, v196
    v_cmp_gt_u32 vcc, 8, v197
    v_add_u32 v197, 14, v196
    v_cmp_gt_u32 s[64:65], 8, v197
    v_cndmask_b32_e64 v12, v198, 0, vcc
    s_nop 0
    v_cndmask_b32_e64 v16, v198, 0, s[64:65]
    v_subrev_u32 v197, 3, v196
    v_cmp_gt_u32 vcc, 8, v197
    v_add_u32 v197, 13, v196
    v_cmp_gt_u32 s[64:65], 8, v197
    v_cndmask_b32_e64 v13, v198, 0, vcc
    s_nop 0
    v_cndmask_b32_e64 v17, v198, 0, s[64:65]
    v_mov_b32 v198, 0xffff
    v_mov_b32 v199, 0xffff0000
    v_cmp_le_i32 vcc, 0, v196
    v_cmp_le_i32 s[64:65], 1, v196
    s_nop 0
    v_cndmask_b32 v18, 0, v198, vcc
    v_cndmask_b32_e64 v197, 0, v199, s[64:65]
    v_or_b32 v18, v18, v197
    v_cmp_le_i32 vcc, 2, v196
    v_cmp_le_i32 s[64:65], 3, v196
    s_nop 0
    v_cndmask_b32 v19, 0, v198, vcc
    v_cndmask_b32_e64 v197, 0, v199, s[64:65]
    v_or_b32 v19, v19, v197
    v_cmp_gt_u32 vcc, 32, v0
    v_mul_u32_u24 v196, 176, v194
    s_add_u32 s13, s12, 110592
    v_cndmask_b32_e64 v20, 0, -1, vcc
    v_add_u32_e64 v196, s13, v196
    v_lshl_add_u32 v21, v195, 3, v196
    v_lshl_add_u32 v22, v195, 1, v196
    v_mov_b64 v[24:25], 0
    v_mov_b64 v[26:27], 0
    s_mov_b32 exec_lo, 0
    s_mov_b32 exec_hi, 0x01000001
    v_mov_b32 v26, 0x3f80
    s_mov_b32 exec_hi, 0x10000010
    v_mov_b32 v26, 0x3f800000
    s_mov_b64 exec, -1
    v_mov_b64 v[6:7], v[2:3]
    v_mov_b64 v[8:9], v[4:5]
    s_mul_i32 s66, s7, 105
    s_cmp_eq_u32 s7, 0
    s_cselect_b32 s68, 0, 7
    s_add_u32 s66, s66, s68
    s_sub_u32 s66, s66, s10
    s_lshl_b32 s67, s9, 2
    s_sub_u32 s66, s66, s67
    s_add_u32 s68, s67, s10
    s_lshl_b32 s69, s8, 5
    s_add_u32 s69, s69, s4
    s_mul_i32 s69, s69, 10240
    v_mul_u32_u24 v194, 205, v0
    v_lshrrev_b32 v194, 11, v194
    v_lshlrev_b32 v33, 4, v0
    v_mul_u32_u24 v195, 2816, v194
    s_mul_i32 s67, s67, 176
    s_add_u32 s67, s67, 110592
    v_add3_u32 v32, v195, v33, s67
    v_lshl_add_u32 v195, v194, 4, 16
    v_cmp_gt_u32 vcc, 60, v0
    s_nop 1
    v_cndmask_b32 v195, -16, v195, vcc
    s_add_u32 s72, s68, 0
    s_and_b32 s73, s72, 15
    s_mul_i32 s73, s73, 20480
    s_lshr_b32 s72, s72, 4
    s_mul_i32 s72, s72, 160
    s_add_u32 s72, s72, s73
    s_add_u32 s40, s72, s69
    s_sub_u32 s72, s66, 0
    v_cmp_le_i32 s[44:45], s72, v195
    s_add_u32 s72, s68, 1
    s_and_b32 s73, s72, 15
    s_mul_i32 s73, s73, 20480
    s_lshr_b32 s72, s72, 4
    s_mul_i32 s72, s72, 160
    s_add_u32 s72, s72, s73
    s_add_u32 s41, s72, s69
    s_sub_u32 s72, s66, 1
    v_cmp_le_i32 s[46:47], s72, v195
    s_add_u32 s72, s68, 2
    s_and_b32 s73, s72, 15
    s_mul_i32 s73, s73, 20480
    s_lshr_b32 s72, s72, 4
    s_mul_i32 s72, s72, 160
    s_add_u32 s72, s72, s73
    s_add_u32 s42, s72, s69
    s_sub_u32 s72, s66, 2
    v_cmp_le_i32 s[48:49], s72, v195
    s_add_u32 s72, s68, 3
    s_and_b32 s73, s72, 15
    s_mul_i32 s73, s73, 20480
    s_lshr_b32 s72, s72, 4
    s_mul_i32 s72, s72, 160
    s_add_u32 s72, s72, s73
    s_add_u32 s43, s72, s69
    s_sub_u32 s72, s66, 3
    v_cmp_le_i32 s[50:51], s72, v195
    v_mul_u32_u24 v195, 16, v194
    v_add3_u32 v34, v195, v33, s67
    v_add_u32 v196, s68, v194
    v_and_b32 v197, 15, v196
    v_mul_u32_u24 v197, 20480, v197
    v_lshrrev_b32 v196, 4, v196
    v_sub_u32 v196, v196, v194
    v_mul_i32_i24 v196, 160, v196
    v_add3_u32 v196, v196, v197, v33
    v_add_u32 v196, s69, v196
    v_mov_b32 v195, 0x80000000
    v_cmp_le_i32 vcc, s66, v194
    s_nop 1
    v_cndmask_b32 v196, v195, v196, vcc
    v_cmp_gt_u32 vcc, 40, v0
    s_nop 1
    v_cndmask_b32 v35, v195, v196, vcc
    s_mul_i32 s64, s5, 20
    s_add_u32 s64, s64, s6
    s_lshl_b32 s64, s64, 7
    s_lshl_b32 s65, s4, 15
    s_add_u32 s64, s64, s65
    s_add_u32 s64, s64, 5816320
    v_lshrrev_b32 v194, 3, v0
    v_lshl_add_u32 v38, v194, 16, s64
    v_and_b32 v194, 7, v0
    v_lshl_add_u32 v38, v194, 4, v38
    s_cmp_eq_u32 s3, 7
    s_cselect_b32 s64, 32, 0
    v_mov_b32 v194, 0x80000000
    v_cmp_gt_u32 vcc, s64, v0
    s_nop 1
    v_cndmask_b32_e64 v38, v194, v38, vcc
    s_mov_b32 s66, 0x3ea52b5c
    s_mov_b32 s67, 0x3ea52b5c
    s_mov_b32 s14, 0
    s_mov_b32 s15, 10
    s_setprio 2
    s_waitcnt lgkmcnt(0)
    s_add_u32 s20, s38, 6062080
    s_addc_u32 s21, s39, 0
    s_load_dwordx2 s[18:19], s[20:21], 0
    s_mov_b64 s[52:53], s[38:39]
    s_mov_b32 s54, 0x690400
    s_mov_b32 s55, 0x20000
    s_barrier
    ds_read_b64_tr_b16 v[222:223], v8 offset:0
    ds_read_b64_tr_b16 v[224:225], v8 offset:3840
    ds_read_b64_tr_b16 v[226:227], v8 offset:160
    ds_read_b64_tr_b16 v[228:229], v8 offset:4000
    ds_read_b64_tr_b16 v[230:231], v8 offset:320
    ds_read_b64_tr_b16 v[232:233], v8 offset:4160
    ds_read_b64_tr_b16 v[234:235], v9 offset:0
    ds_read_b64_tr_b16 v[236:237], v9 offset:3840
    ds_read_b128 v[166:169], v6 offset:0
    ds_read_b128 v[170:173], v6 offset:128
    ds_read_b128 v[174:177], v6 offset:256
    ds_read_b128 v[178:181], v6 offset:384
    ds_read_b128 v[182:185], v6 offset:512
    ds_read_b128 v[186:189], v6 offset:640
    ds_read_b128 v[190:193], v6 offset:768
    s_waitcnt lgkmcnt(0)
    s_branch L_qc_in
.p2align 3
L_qc_loop:
    v_mfma_f32_16x16x32_bf16 v[162:165], v[250:253], v[218:221], v[162:165]
L_qc_in:
    v_mfma_f32_16x16x32_bf16 v[40:43], v[222:225], v[166:169], v[40:43]
    ds_read_b64_tr_b16 v[238:239], v8 offset:15360
    v_mfma_f32_16x16x32_bf16 v[82:85], v[226:229], v[166:169], v[82:85]
    ds_read_b64_tr_b16 v[240:241], v8 offset:19200
    v_mfma_f32_16x16x32_bf16 v[110:113], v[166:169], v[230:233], v[110:113]
    ds_read_b64_tr_b16 v[242:243], v8 offset:15520
    v_mfma_f32_16x16x32_bf16 v[138:141], v[234:237], v[166:169], v[138:141]
    ds_read_b64_tr_b16 v[244:245], v8 offset:19360
    v_mfma_f32_16x16x32_bf16 v[46:49], v[222:225], v[170:173], v[46:49]
    ds_read_b64_tr_b16 v[246:247], v8 offset:15680
    v_mfma_f32_16x16x32_bf16 v[86:89], v[226:229], v[170:173], v[86:89]
    ds_read_b64_tr_b16 v[248:249], v8 offset:19520
    v_mfma_f32_16x16x32_bf16 v[114:117], v[170:173], v[230:233], v[114:117]
    ds_read_b64_tr_b16 v[250:251], v9 offset:15360
    v_mfma_f32_16x16x32_bf16 v[142:145], v[234:237], v[170:173], v[142:145]
    ds_read_b64_tr_b16 v[252:253], v9 offset:19200
    v_mfma_f32_16x16x32_bf16 v[52:55], v[222:225], v[174:177], v[52:55]
    ds_read_b128 v[194:197], v7 offset:0
    v_mfma_f32_16x16x32_bf16 v[90:93], v[226:229], v[174:177], v[90:93]
    ds_read_b128 v[198:201], v7 offset:128
    v_mfma_f32_16x16x32_bf16 v[118:121], v[174:177], v[230:233], v[118:121]
    ds_read_b128 v[202:205], v7 offset:256
    v_mfma_f32_16x16x32_bf16 v[146:149], v[234:237], v[174:177], v[146:149]
    ds_read_b128 v[206:209], v7 offset:384
    v_mfma_f32_16x16x32_bf16 v[58:61], v[222:225], v[178:181], v[58:61]
    ds_read_b128 v[210:213], v7 offset:512
    v_mfma_f32_16x16x32_bf16 v[94:97], v[226:229], v[178:181], v[94:97]
    ds_read_b128 v[214:217], v7 offset:640
    v_mfma_f32_16x16x32_bf16 v[122:125], v[178:181], v[230:233], v[122:125]
    ds_read_b128 v[218:221], v7 offset:768
    v_mfma_f32_16x16x32_bf16 v[150:153], v[234:237], v[178:181], v[150:153]
    s_sub_u32 s15, s15, 1
    s_nop 0
    v_mfma_f32_16x16x32_bf16 v[64:67], v[222:225], v[182:185], v[64:67]
    s_add_u32 s14, s14, 45056
    v_mfma_f32_16x16x32_bf16 v[98:101], v[226:229], v[182:185], v[98:101]
    s_cmp_eq_u32 s14, 135168
    v_mfma_f32_16x16x32_bf16 v[126:129], v[182:185], v[230:233], v[126:129]
    s_cselect_b32 s14, 0, s14
    s_cmp_eq_u32 s15, 0
    v_mfma_f32_16x16x32_bf16 v[154:157], v[234:237], v[182:185], v[154:157]
    v_add_u32_e64 v6, s14, v2
    v_mfma_f32_16x16x32_bf16 v[70:73], v[222:225], v[186:189], v[70:73]
    v_add_u32_e64 v7, s14, v3
    v_mfma_f32_16x16x32_bf16 v[102:105], v[226:229], v[186:189], v[102:105]
    v_add_u32_e64 v8, s14, v4
    v_mfma_f32_16x16x32_bf16 v[130:133], v[186:189], v[230:233], v[130:133]
    v_add_u32_e64 v9, s14, v5
    v_mfma_f32_16x16x32_bf16 v[158:161], v[234:237], v[186:189], v[158:161]
    v_mfma_f32_16x16x32_bf16 v[76:79], v[222:225], v[190:193], v[76:79]
    v_mfma_f32_16x16x32_bf16 v[106:109], v[226:229], v[190:193], v[106:109]
    v_mfma_f32_16x16x32_bf16 v[134:137], v[190:193], v[230:233], v[134:137]
    s_waitcnt lgkmcnt(0)
    s_cbranch_scc1 L_qc_last
    v_mfma_f32_16x16x32_bf16 v[162:165], v[234:237], v[190:193], v[162:165]
    s_barrier
    s_nop 0
    v_mfma_f32_16x16x32_bf16 v[40:43], v[238:241], v[194:197], v[40:43]
    ds_read_b64_tr_b16 v[222:223], v8 offset:0
    v_mfma_f32_16x16x32_bf16 v[82:85], v[242:245], v[194:197], v[82:85]
    ds_read_b64_tr_b16 v[224:225], v8 offset:3840
    v_mfma_f32_16x16x32_bf16 v[110:113], v[194:197], v[246:249], v[110:113]
    ds_read_b64_tr_b16 v[226:227], v8 offset:160
    v_mfma_f32_16x16x32_bf16 v[138:141], v[250:253], v[194:197], v[138:141]
    ds_read_b64_tr_b16 v[228:229], v8 offset:4000
    v_mfma_f32_16x16x32_bf16 v[46:49], v[238:241], v[198:201], v[46:49]
    ds_read_b64_tr_b16 v[230:231], v8 offset:320
    v_mfma_f32_16x16x32_bf16 v[86:89], v[242:245], v[198:201], v[86:89]
    ds_read_b64_tr_b16 v[232:233], v8 offset:4160
    v_mfma_f32_16x16x32_bf16 v[114:117], v[198:201], v[246:249], v[114:117]
    ds_read_b64_tr_b16 v[234:235], v9 offset:0
    v_mfma_f32_16x16x32_bf16 v[142:145], v[250:253], v[198:201], v[142:145]
    ds_read_b64_tr_b16 v[236:237], v9 offset:3840
    v_mfma_f32_16x16x32_bf16 v[52:55], v[238:241], v[202:205], v[52:55]
    ds_read_b128 v[166:169], v6 offset:0
    v_mfma_f32_16x16x32_bf16 v[90:93], v[242:245], v[202:205], v[90:93]
    ds_read_b128 v[170:173], v6 offset:128
    v_mfma_f32_16x16x32_bf16 v[118:121], v[202:205], v[246:249], v[118:121]
    ds_read_b128 v[174:177], v6 offset:256
    v_mfma_f32_16x16x32_bf16 v[146:149], v[250:253], v[202:205], v[146:149]
    ds_read_b128 v[178:181], v6 offset:384
    v_mfma_f32_16x16x32_bf16 v[58:61], v[238:241], v[206:209], v[58:61]
    ds_read_b128 v[182:185], v6 offset:512
    v_mfma_f32_16x16x32_bf16 v[94:97], v[242:245], v[206:209], v[94:97]
    ds_read_b128 v[186:189], v6 offset:640
    v_mfma_f32_16x16x32_bf16 v[122:125], v[206:209], v[246:249], v[122:125]
    ds_read_b128 v[190:193], v6 offset:768
    v_mfma_f32_16x16x32_bf16 v[150:153], v[250:253], v[206:209], v[150:153]
    v_mfma_f32_16x16x32_bf16 v[64:67], v[238:241], v[210:213], v[64:67]
    v_mfma_f32_16x16x32_bf16 v[98:101], v[242:245], v[210:213], v[98:101]
    v_mfma_f32_16x16x32_bf16 v[126:129], v[210:213], v[246:249], v[126:129]
    v_mfma_f32_16x16x32_bf16 v[154:157], v[250:253], v[210:213], v[154:157]
    v_mfma_f32_16x16x32_bf16 v[70:73], v[238:241], v[214:217], v[70:73]
    v_mfma_f32_16x16x32_bf16 v[102:105], v[242:245], v[214:217], v[102:105]
    v_mfma_f32_16x16x32_bf16 v[130:133], v[214:217], v[246:249], v[130:133]
    v_mfma_f32_16x16x32_bf16 v[158:161], v[250:253], v[214:217], v[158:161]
    v_mfma_f32_16x16x32_bf16 v[76:79], v[238:241], v[218:221], v[76:79]
    v_mfma_f32_16x16x32_bf16 v[106:109], v[242:245], v[218:221], v[106:109]
    v_mfma_f32_16x16x32_bf16 v[134:137], v[218:221], v[246:249], v[134:137]
    s_waitcnt lgkmcnt(0)
    s_branch L_qc_loop
L_qc_last:
    v_mfma_f32_16x16x32_bf16 v[162:165], v[234:237], v[190:193], v[162:165]
    s_mov_b64 exec, 1
    ds_add_u32 v36, v37 offset:4
    s_mov_b64 exec, -1
    s_bitcmp0_b32 s2, 0
    s_cselect_b32 s64, s18, s19
    s_add_u32 s64, s64, 1
    v_mov_b32 v39, s64
    v_mov_b32 v2, s64
    v_mov_b32 v3, s64
    v_mov_b32 v4, s64
    v_mov_b32 v5, s64
    s_cmp_eq_u32 s3, 7
    v_mfma_f32_16x16x32_bf16 v[102:105], v[242:245], v[214:217], v[102:105]
    v_mfma_f32_16x16x32_bf16 v[106:109], v[242:245], v[218:221], v[106:109]
    v_mfma_f32_16x16x32_bf16 v[82:85], v[242:245], v[194:197], v[82:85]
    v_mfma_f32_16x16x32_bf16 v[86:89], v[242:245], v[198:201], v[86:89]
    v_mfma_f32_16x16x32_bf16 v[90:93], v[242:245], v[202:205], v[90:93]
    v_mfma_f32_16x16x32_bf16 v[94:97], v[242:245], v[206:209], v[94:97]
    v_mfma_f32_16x16x32_bf16 v[98:101], v[242:245], v[210:213], v[98:101]
    v_mfma_f32_16x16x32_bf16 v[158:161], v[250:253], v[214:217], v[158:161]
    s_nop 0
    v_cvt_pk_bf16_f32 v102, v102, v103
    v_mfma_f32_16x16x32_bf16 v[162:165], v[250:253], v[218:221], v[162:165]
    v_cvt_pk_bf16_f32 v106, v106, v107
    v_cvt_pk_bf16_f32 v82, v82, v83
    v_mfma_f32_16x16x32_bf16 v[138:141], v[250:253], v[194:197], v[138:141]
    v_cvt_pk_bf16_f32 v86, v86, v87
    v_cvt_pk_bf16_f32 v90, v90, v91
    v_mfma_f32_16x16x32_bf16 v[142:145], v[250:253], v[198:201], v[142:145]
    v_cvt_pk_bf16_f32 v94, v94, v95
    v_cvt_pk_bf16_f32 v98, v98, v99
    v_mfma_f32_16x16x32_bf16 v[146:149], v[250:253], v[202:205], v[146:149]
    v_cvt_pk_bf16_f32 v103, v104, v105
    v_cvt_pk_bf16_f32 v107, v108, v109
    v_mfma_f32_16x16x32_bf16 v[150:153], v[250:253], v[206:209], v[150:153]
    v_cvt_pk_bf16_f32 v83, v84, v85
    v_cvt_pk_bf16_f32 v87, v88, v89
    v_mfma_f32_16x16x32_bf16 v[154:157], v[250:253], v[210:213], v[154:157]
    v_cvt_pk_bf16_f32 v91, v92, v93
    v_cvt_pk_bf16_f32 v95, v96, v97
    v_mfma_f32_16x16x32_bf16 v[76:79], v[238:241], v[218:221], v[76:79]
    v_cvt_pk_bf16_f32 v99, v100, v101
    v_cvt_pk_bf16_f32 v74, v158, v159
    v_mfma_f32_16x16x32_bf16 v[46:49], v[238:241], v[198:201], v[46:49]
    v_cvt_pk_bf16_f32 v105, v160, v161
    v_cvt_pk_bf16_f32 v80, v162, v163
    v_mfma_f32_16x16x32_bf16 v[52:55], v[238:241], v[202:205], v[52:55]
    v_cvt_pk_bf16_f32 v109, v164, v165
    v_cvt_pk_bf16_f32 v44, v138, v139
    v_mfma_f32_16x16x32_bf16 v[58:61], v[238:241], v[206:209], v[58:61]
    v_cvt_pk_bf16_f32 v85, v140, v141
    v_cvt_pk_bf16_f32 v50, v142, v143
    v_mfma_f32_16x16x32_bf16 v[64:67], v[238:241], v[210:213], v[64:67]
    v_cvt_pk_bf16_f32 v89, v144, v145
    v_cvt_pk_bf16_f32 v56, v146, v147
    v_mfma_f32_16x16x32_bf16 v[70:73], v[238:241], v[214:217], v[70:73]
    v_cvt_pk_bf16_f32 v93, v148, v149
    v_cvt_pk_bf16_f32 v62, v150, v151
    v_mfma_f32_16x16x32_bf16 v[40:43], v[238:241], v[194:197], v[40:43]
    v_cvt_pk_bf16_f32 v97, v152, v153
    v_cvt_pk_bf16_f32 v68, v154, v155
    v_mfma_f32_16x16x32_bf16 v[134:137], v[218:221], v[246:249], v[134:137]
    v_cvt_pk_bf16_f32 v101, v156, v157
    v_permlane16_swap_b32 v74, v105
    v_mfma_f32_16x16x32_bf16 v[114:117], v[198:201], v[246:249], v[114:117]
    v_permlane16_swap_b32 v80, v109
    v_mfma_f32_16x16x32_bf16 v[118:121], v[202:205], v[246:249], v[118:121]
    v_permlane16_swap_b32 v44, v85
    v_mfma_f32_16x16x32_bf16 v[122:125], v[206:209], v[246:249], v[122:125]
    v_permlane16_swap_b32 v50, v89
    v_mfma_f32_16x16x32_bf16 v[126:129], v[210:213], v[246:249], v[126:129]
    v_permlane16_swap_b32 v56, v93
    v_mfma_f32_16x16x32_bf16 v[130:133], v[214:217], v[246:249], v[130:133]
    v_permlane16_swap_b32 v62, v97
    v_mfma_f32_16x16x32_bf16 v[110:113], v[194:197], v[246:249], v[110:113]
    v_permlane16_swap_b32_e64 v68, v101
    v_cvt_pk_bf16_f32 v79, v78, v79
    v_cvt_pk_bf16_f32 v49, v48, v49
    v_cvt_pk_bf16_f32 v55, v54, v55
    v_cvt_pk_bf16_f32 v61, v60, v61
    v_cvt_pk_bf16_f32 v67, v66, v67
    v_cvt_pk_bf16_f32 v73, v72, v73
    v_and_b32 v104, v20, v105
    v_cvt_pk_bf16_f32 v78, v76, v77
    v_and_b32 v108, v20, v109
    v_cvt_pk_bf16_f32 v43, v42, v43
    v_mfma_f32_16x16x32_bf16 v[162:165], v[78:81], v[24:27], v[28:31]
    v_and_b32_e64 v84, v20, v85
    v_cvt_pk_bf16_f32 v48, v46, v47
    v_mfma_f32_16x16x32_bf16 v[190:193], v[106:109], v[78:81], v[10:13]
    v_and_b32_e64 v88, v20, v89
    v_cvt_pk_bf16_f32 v54, v52, v53
    v_mfma_f32_16x16x32_bf16 v[142:145], v[48:51], v[24:27], v[28:31]
    v_and_b32_e64 v92, v20, v93
    v_cvt_pk_bf16_f32 v60, v58, v59
    v_mfma_f32_16x16x32_bf16 v[170:173], v[86:89], v[48:51], v[10:13]
    v_and_b32_e64 v96, v20, v97
    v_cvt_pk_bf16_f32 v66, v64, v65
    v_mfma_f32_16x16x32_bf16 v[174:177], v[90:93], v[54:57], v[10:13]
    v_and_b32_e64 v100, v20, v101
    v_cvt_pk_bf16_f32 v72, v70, v71
    v_mfma_f32_16x16x32_bf16 v[178:181], v[94:97], v[60:63], v[10:13]
    v_cvt_pk_bf16_f32 v42, v40, v41
    v_cvt_pk_bf16_f32 v236, v134, v135
    v_mfma_f32_16x16x32_bf16 v[182:185], v[98:101], v[66:69], v[10:13]
    v_cvt_pk_bf16_f32 v237, v136, v137
    v_cvt_pk_bf16_f32 v226, v114, v115
    v_mfma_f32_16x16x32_bf16 v[134:137], v[102:105], v[78:81], v[14:17]
    v_cvt_pk_bf16_f32 v227, v116, v117
    v_cvt_pk_bf16_f32 v228, v118, v119
    v_mfma_f32_16x16x32_bf16 v[114:117], v[82:85], v[48:51], v[14:17]
    v_cvt_pk_bf16_f32 v229, v120, v121
    v_cvt_pk_bf16_f32 v230, v122, v123
    v_mfma_f32_16x16x32_bf16 v[118:121], v[86:89], v[54:57], v[14:17]
    v_cvt_pk_bf16_f32 v231, v124, v125
    v_cvt_pk_bf16_f32 v232, v126, v127
    v_mfma_f32_16x16x32_bf16 v[122:125], v[90:93], v[60:63], v[14:17]
    v_cvt_pk_bf16_f32 v233, v128, v129
    v_cvt_pk_bf16_f32 v234, v130, v131
    v_mfma_f32_16x16x32_bf16 v[126:129], v[94:97], v[66:69], v[14:17]
    v_cvt_pk_bf16_f32 v235, v132, v133
    v_max_f32 v190, v190, v134
    v_mfma_f32_16x16x32_bf16 v[186:189], v[102:105], v[72:75], v[10:13]
    v_max_f32 v191, v191, v135
    v_max_f32 v192, v192, v136
    v_mfma_f32_16x16x32_bf16 v[130:133], v[98:101], v[72:75], v[14:17]
    v_max_f32 v170, v170, v114
    v_max_f32 v171, v171, v115
    v_mfma_f32_16x16x32_bf16 v[166:169], v[82:85], v[42:45], v[10:13]
    v_max_f32 v172, v172, v116
    v_max_f32 v174, v174, v118
    v_mfma_f32_16x16x32_bf16 v[138:141], v[42:45], v[24:27], v[28:31]
    v_max_f32 v175, v175, v119
    v_max_f32 v176, v176, v120
    v_mfma_f32_16x16x32_bf16 v[146:149], v[54:57], v[24:27], v[28:31]
    v_max_f32 v178, v178, v122
    v_max_f32 v179, v179, v123
    v_mfma_f32_16x16x32_bf16 v[150:153], v[60:63], v[24:27], v[28:31]
    v_max_f32 v180, v180, v124
    v_max_f32 v182, v182, v126
    v_mfma_f32_16x16x32_bf16 v[154:157], v[66:69], v[24:27], v[28:31]
    v_max_f32 v183, v183, v127
    v_max_f32 v184, v184, v128
    v_mfma_f32_16x16x32_bf16 v[158:161], v[72:75], v[24:27], v[28:31]
    v_max_f32 v186, v186, v130
    v_max_f32 v187, v187, v131
    v_max_f32 v188, v188, v132
    v_max_f32_e64 v193, v193, v137
    v_max3_f32 v76, v190, v191, v192
    v_max3_f32 v40, v166, v167, v168
    v_max_f32 v173, v173, v117
    v_max3_f32 v46, v170, v171, v172
    v_max_f32 v177, v177, v121
    v_max3_f32 v52, v174, v175, v176
    v_max_f32 v181, v181, v125
    v_max3_f32 v58, v178, v179, v180
    v_max_f32 v185, v185, v129
    v_max3_f32 v64, v182, v183, v184
    v_max_f32 v189, v189, v133
    v_max3_f32 v70, v186, v187, v188
    v_max_f32 v76, v76, v193
    v_max_f32 v40, v40, v169
    v_max_f32 v46, v46, v173
    v_max_f32 v52, v52, v177
    v_max_f32 v58, v58, v181
    v_max_f32 v64, v64, v185
    v_max_f32 v70, v70, v189
    v_mov_b32 v77, v76
    v_permlane16_swap_b32 v40, v46
    v_permlane16_swap_b32 v52, v58
    v_permlane16_swap_b32 v64, v70
    v_permlane16_swap_b32 v76, v77
    v_max_f32 v40, v40, v46
    v_max_f32 v52, v52, v58
    v_max_f32 v64, v64, v70
    v_max_f32 v76, v76, v77
    v_permlane32_swap_b32 v40, v52
    v_max_f32 v40, v40, v52
    v_permlane32_swap_b32 v64, v76
    v_max_f32_e64 v64, v64, v76
    v_mul_f32 v52, 0xbea52b5c, v40
    v_mul_f32 v76, 0xbea52b5c, v64
    v_mul_f32 v40, 0xbea52b5c, v40
    v_mul_f32 v64, 0xbea52b5c, v64
    v_cvt_pk_bf16_f32 v240, v138, v139
    v_permlane32_swap_b32 v40, v52
    v_permlane32_swap_b32 v64, v76
    v_mov_b32 v46, v40
    v_mov_b32 v58, v52
    v_mov_b32 v70, v64
    v_permlane16_swap_b32 v40, v46
    v_permlane16_swap_b32 v52, v58
    v_permlane16_swap_b32 v64, v70
    v_cvt_pk_bf16_f32 v241, v140, v141
    v_cvt_pk_bf16_f32 v242, v142, v143
    v_cvt_pk_bf16_f32 v243, v144, v145
    v_cvt_pk_bf16_f32 v244, v146, v147
    v_cvt_pk_bf16_f32 v245, v148, v149
    v_cvt_pk_bf16_f32 v246, v150, v151
    v_cvt_pk_bf16_f32 v247, v152, v153
    v_cvt_pk_bf16_f32 v248, v154, v155
    v_cvt_pk_bf16_f32 v249, v156, v157
    v_cvt_pk_bf16_f32 v250, v158, v159
    v_cvt_pk_bf16_f32 v251, v160, v161
    v_cvt_pk_bf16_f32 v252, v162, v163
    v_cvt_pk_bf16_f32 v253, v164, v165
    v_cvt_pk_bf16_f32 v224, v110, v111
    v_cvt_pk_bf16_f32 v225, v112, v113
    v_pk_fma_f32 v[166:167], v[166:167], s[66:67], v[40:41] op_sel_hi:[1,1,0]
    v_pk_fma_f32 v[168:169], v[168:169], s[66:67], v[40:41] op_sel_hi:[1,1,0]
    v_exp_f32 v166, v166
    v_exp_f32 v167, v167
    v_exp_f32 v168, v168
    v_exp_f32 v169, v169
    v_cvt_pk_bf16_f32 v166, v166, v167
    v_cvt_pk_bf16_f32 v167, v168, v169
    v_and_b32 v196, v18, v166
    v_and_b32 v197, v19, v167
    v_xor_b32 v194, v196, v166
    v_xor_b32 v195, v197, v167
    v_pk_fma_f32 v[170:171], v[170:171], s[66:67], v[46:47] op_sel_hi:[1,1,0]
    v_pk_fma_f32 v[172:173], v[172:173], s[66:67], v[46:47] op_sel_hi:[1,1,0]
    v_mfma_f32_16x16x32_bf16 v[138:141], v[238:241], v[194:197], 0
    v_exp_f32 v170, v170
    v_mfma_f32_16x16x32_bf16 v[110:113], v[222:225], v[194:197], 0
    v_exp_f32 v171, v171
    v_exp_f32 v172, v172
    v_exp_f32 v173, v173
    v_cvt_pk_bf16_f32 v170, v170, v171
    v_cvt_pk_bf16_f32 v171, v172, v173
    v_and_b32 v200, v18, v170
    v_rcp_f32 v139, v139
    v_and_b32_e64 v201, v19, v171
    v_pk_mul_f32 v[110:111], v[110:111], v[138:139] op_sel:[0,1] op_sel_hi:[1,1]
    v_pk_mul_f32 v[112:113], v[112:113], v[138:139] op_sel:[0,1] op_sel_hi:[1,1]
    v_mul_f32_e64 v140, v138, v139
    v_cvt_pk_bf16_f32 v110, v110, v111
    v_cvt_pk_bf16_f32 v111, v112, v113
    v_cvt_pk_bf16_f32 v140, v140, v140
    ds_write_b64 v21, v[110:111] offset:0
    ds_write_b16 v22, v140 offset:32
    v_xor_b32 v198, v200, v170
    v_xor_b32 v199, v201, v171
    v_pk_fma_f32 v[174:175], v[174:175], s[66:67], v[52:53] op_sel_hi:[1,1,0]
    v_pk_fma_f32 v[176:177], v[176:177], s[66:67], v[52:53] op_sel_hi:[1,1,0]
    v_mfma_f32_16x16x32_bf16 v[142:145], v[240:243], v[198:201], 0
    v_exp_f32 v174, v174
    v_mfma_f32_16x16x32_bf16 v[114:117], v[224:227], v[198:201], 0
    v_exp_f32 v175, v175
    v_exp_f32 v176, v176
    v_exp_f32 v177, v177
    v_cvt_pk_bf16_f32 v174, v174, v175
    v_cvt_pk_bf16_f32 v175, v176, v177
    v_and_b32 v204, v18, v174
    v_rcp_f32 v143, v143
    v_and_b32_e64 v205, v19, v175
    v_pk_mul_f32 v[114:115], v[114:115], v[142:143] op_sel:[0,1] op_sel_hi:[1,1]
    v_pk_mul_f32 v[116:117], v[116:117], v[142:143] op_sel:[0,1] op_sel_hi:[1,1]
    v_mul_f32_e64 v144, v142, v143
    v_cvt_pk_bf16_f32 v114, v114, v115
    v_cvt_pk_bf16_f32 v115, v116, v117
    v_cvt_pk_bf16_f32 v144, v144, v144
    ds_write_b64 v21, v[114:115] offset:2976
    ds_write_b16 v22, v144 offset:3008
    v_xor_b32 v202, v204, v174
    v_xor_b32 v203, v205, v175
    v_pk_fma_f32 v[178:179], v[178:179], s[66:67], v[58:59] op_sel_hi:[1,1,0]
    v_pk_fma_f32 v[180:181], v[180:181], s[66:67], v[58:59] op_sel_hi:[1,1,0]
    v_mfma_f32_16x16x32_bf16 v[146:149], v[242:245], v[202:205], 0
    v_exp_f32 v178, v178
    v_mfma_f32_16x16x32_bf16 v[118:121], v[226:229], v[202:205], 0
    v_exp_f32 v179, v179
    v_exp_f32 v180, v180
    v_exp_f32 v181, v181
    v_cvt_pk_bf16_f32 v178, v178, v179
    v_cvt_pk_bf16_f32 v179, v180, v181
    v_and_b32 v208, v18, v178
    v_rcp_f32 v147, v147
    v_and_b32_e64 v209, v19, v179
    v_pk_mul_f32 v[118:119], v[118:119], v[146:147] op_sel:[0,1] op_sel_hi:[1,1]
    v_pk_mul_f32 v[120:121], v[120:121], v[146:147] op_sel:[0,1] op_sel_hi:[1,1]
    v_mul_f32_e64 v148, v146, v147
    v_cvt_pk_bf16_f32 v118, v118, v119
    v_cvt_pk_bf16_f32 v119, v120, v121
    v_cvt_pk_bf16_f32 v148, v148, v148
    ds_write_b64 v21, v[118:119] offset:5952
    ds_write_b16 v22, v148 offset:5984
    v_xor_b32 v206, v208, v178
    v_xor_b32 v207, v209, v179
    v_pk_fma_f32 v[182:183], v[182:183], s[66:67], v[64:65] op_sel_hi:[1,1,0]
    v_pk_fma_f32 v[184:185], v[184:185], s[66:67], v[64:65] op_sel_hi:[1,1,0]
    v_mfma_f32_16x16x32_bf16 v[150:153], v[244:247], v[206:209], 0
    v_exp_f32 v182, v182
    v_mfma_f32_16x16x32_bf16 v[122:125], v[228:231], v[206:209], 0
    v_exp_f32 v183, v183
    v_exp_f32 v184, v184
    v_exp_f32 v185, v185
    v_cvt_pk_bf16_f32 v182, v182, v183
    v_cvt_pk_bf16_f32 v183, v184, v185
    v_and_b32 v212, v18, v182
    v_rcp_f32 v151, v151
    v_and_b32_e64 v213, v19, v183
    v_pk_mul_f32 v[122:123], v[122:123], v[150:151] op_sel:[0,1] op_sel_hi:[1,1]
    v_pk_mul_f32 v[124:125], v[124:125], v[150:151] op_sel:[0,1] op_sel_hi:[1,1]
    v_mul_f32_e64 v152, v150, v151
    v_cvt_pk_bf16_f32 v122, v122, v123
    v_cvt_pk_bf16_f32 v123, v124, v125
    v_cvt_pk_bf16_f32 v152, v152, v152
    ds_write_b64 v21, v[122:123] offset:8928
    ds_write_b16 v22, v152 offset:8960
    v_xor_b32 v210, v212, v182
    v_xor_b32 v211, v213, v183
    v_pk_fma_f32 v[186:187], v[186:187], s[66:67], v[70:71] op_sel_hi:[1,1,0]
    v_pk_fma_f32 v[188:189], v[188:189], s[66:67], v[70:71] op_sel_hi:[1,1,0]
    v_mfma_f32_16x16x32_bf16 v[154:157], v[246:249], v[210:213], 0
    v_exp_f32 v186, v186
    v_mfma_f32_16x16x32_bf16 v[126:129], v[230:233], v[210:213], 0
    v_exp_f32 v187, v187
    v_exp_f32 v188, v188
    s_cbranch_scc0 L_noflg
    buffer_store_dwordx4 v[2:5], v38, s[52:55], 0 offen sc0 sc1
L_noflg:
    v_exp_f32_e64 v189, v189
    v_cvt_pk_bf16_f32 v186, v186, v187
    v_cvt_pk_bf16_f32 v187, v188, v189
    v_and_b32 v216, v18, v186
    v_rcp_f32 v155, v155
    v_and_b32_e64 v217, v19, v187
    v_pk_mul_f32 v[126:127], v[126:127], v[154:155] op_sel:[0,1] op_sel_hi:[1,1]
    v_pk_mul_f32 v[128:129], v[128:129], v[154:155] op_sel:[0,1] op_sel_hi:[1,1]
    v_mul_f32_e64 v156, v154, v155
    v_cvt_pk_bf16_f32 v126, v126, v127
    v_cvt_pk_bf16_f32 v127, v128, v129
    v_cvt_pk_bf16_f32 v156, v156, v156
    ds_write_b64 v21, v[126:127] offset:11904
    ds_write_b16 v22, v156 offset:11936
    v_xor_b32 v214, v216, v186
    v_xor_b32 v215, v217, v187
    v_pk_fma_f32 v[190:191], v[190:191], s[66:67], v[76:77] op_sel_hi:[1,1,0]
    v_pk_fma_f32 v[192:193], v[192:193], s[66:67], v[76:77] op_sel_hi:[1,1,0]
    v_mfma_f32_16x16x32_bf16 v[158:161], v[248:251], v[214:217], 0
    v_exp_f32 v190, v190
    v_mfma_f32_16x16x32_bf16 v[130:133], v[232:235], v[214:217], 0
    v_exp_f32 v191, v191
    v_exp_f32 v192, v192
    v_exp_f32 v193, v193
    v_cvt_pk_bf16_f32 v190, v190, v191
    v_cvt_pk_bf16_f32 v191, v192, v193
    v_and_b32 v220, v18, v190
    v_rcp_f32 v159, v159
    v_and_b32_e64 v221, v19, v191
    v_pk_mul_f32 v[130:131], v[130:131], v[158:159] op_sel:[0,1] op_sel_hi:[1,1]
    v_pk_mul_f32 v[132:133], v[132:133], v[158:159] op_sel:[0,1] op_sel_hi:[1,1]
    v_mul_f32_e64 v160, v158, v159
    v_cvt_pk_bf16_f32 v130, v130, v131
    v_cvt_pk_bf16_f32 v131, v132, v133
    v_cvt_pk_bf16_f32 v160, v160, v160
    ds_write_b64 v21, v[130:131] offset:14880
    ds_write_b16 v22, v160 offset:14912
    v_xor_b32 v218, v220, v190
    v_xor_b32 v219, v221, v191
    s_nop 1
    v_mfma_f32_16x16x32_bf16 v[162:165], v[250:253], v[218:221], 0
    v_mfma_f32_16x16x32_bf16 v[134:137], v[234:237], v[218:221], 0
    s_nop 6
    v_rcp_f32 v163, v163
    s_nop 0
    v_pk_mul_f32 v[134:135], v[134:135], v[162:163] op_sel:[0,1] op_sel_hi:[1,1]
    v_pk_mul_f32 v[136:137], v[136:137], v[162:163] op_sel:[0,1] op_sel_hi:[1,1]
    v_mul_f32_e64 v164, v162, v163
    v_cvt_pk_bf16_f32 v134, v134, v135
    v_cvt_pk_bf16_f32 v135, v136, v137
    v_cvt_pk_bf16_f32 v164, v164, v164
    ds_write_b64 v21, v[134:135] offset:17856
    ds_write_b16 v22, v164 offset:17888
    s_waitcnt lgkmcnt(0)
    s_barrier
    ds_read_b128 v[166:169], v32 offset:2976
    ds_read_b128 v[170:173], v32 offset:3152
    ds_read_b128 v[174:177], v32 offset:3328
    ds_read_b128 v[178:181], v32 offset:3504
    ds_read_b128 v[182:185], v34
    s_mov_b64 exec, s[44:45]
    s_waitcnt lgkmcnt(4)
    buffer_store_dwordx4 v[166:169], v33, s[52:55], s40 offen offset:160 sc1
    s_mov_b64 exec, s[46:47]
    s_waitcnt lgkmcnt(3)
    buffer_store_dwordx4 v[170:173], v33, s[52:55], s41 offen offset:160 sc1
    s_mov_b64 exec, s[48:49]
    s_waitcnt lgkmcnt(2)
    buffer_store_dwordx4 v[174:177], v33, s[52:55], s42 offen offset:160 sc1
    s_mov_b64 exec, s[50:51]
    s_waitcnt lgkmcnt(1)
    buffer_store_dwordx4 v[178:181], v33, s[52:55], s43 offen offset:160 sc1
    s_mov_b64 exec, -1
    s_waitcnt lgkmcnt(0)
    buffer_store_dwordx4 v[182:185], v35, s[52:55], 0 offen sc1
    s_mov_b64 exec, 1
    ds_add_u32 v36, v37 offset:12
    s_mov_b64 exec, -1
    s_barrier
    s_endpgm
L_dft3:
    s_add_u32 s20, s38, 6062080
    s_addc_u32 s21, s39, 0
    s_load_dwordx2 s[18:19], s[20:21], 0
    s_mov_b64 s[52:53], s[38:39]
    s_mov_b32 s54, 0x690400
    s_mov_b32 s55, 0x20000
    v_lshrrev_b32 v11, 4, v0
    v_xor_b32 v11, v11, v10
    s_and_b32 s9, s3, 1
    s_lshl_b32 s9, s9, 2
    v_xor_b32 v11, s9, v11
    v_lshlrev_b32 v12, 7, v8
    v_lshl_add_u32 v12, v11, 4, v12
    v_add_u32 v3, s15, v12
    s_lshl_b32 s11, s8, 31
    s_or_b32 s11, s11, 0x3f803f80
    s_mov_b32 s12, 0x05040100
    s_mov_b32 s13, 0x07060302
    v_mov_b64 v[28:29], -1
    s_cmp_lt_u32 s3, 4
    s_cbranch_scc1 L_fold
    s_setprio 2
    v_and_b32 v30, 31, v0
    v_lshrrev_b32 v31, 5, v0
    v_cvt_f32_u32 v32, v30
    v_cvt_f32_u32 v34, v31
    v_mul_f32_e64 v33, v34, v32
    v_mul_f32 v33, 0x3e000000, v33
    v_fmamk_f32 v240, v32, 0x0, v33
    v_fmamk_f32 v241, v32, 0x3d000000, v33
    v_cos_f32 v242, v240
    v_sin_f32 v244, v240
    v_cos_f32 v243, v241
    v_sin_f32 v245, v241
    v_cvt_pk_bf16_f32 v36, v242, v243
    v_cvt_pk_bf16_f32 v52, v244, v245
    v_xor_b32 v44, 0x80008000, v52
    v_fmamk_f32 v240, v32, 0x3d800000, v33
    v_fmamk_f32 v241, v32, 0x3dc00000, v33
    v_cos_f32 v242, v240
    v_sin_f32 v244, v240
    v_cos_f32 v243, v241
    v_sin_f32 v245, v241
    v_cvt_pk_bf16_f32 v37, v242, v243
    v_cvt_pk_bf16_f32 v53, v244, v245
    v_xor_b32 v45, 0x80008000, v53
    v_fmamk_f32 v240, v32, 0x3e800000, v33
    v_fmamk_f32 v241, v32, 0x3e900000, v33
    v_cos_f32 v242, v240
    v_sin_f32 v244, v240
    v_cos_f32 v243, v241
    v_sin_f32 v245, v241
    v_cvt_pk_bf16_f32 v38, v242, v243
    v_cvt_pk_bf16_f32 v54, v244, v245
    v_xor_b32 v46, 0x80008000, v54
    v_fmamk_f32 v240, v32, 0x3ea00000, v33
    v_fmamk_f32 v241, v32, 0x3eb00000, v33
    v_cos_f32 v242, v240
    v_sin_f32 v244, v240
    v_cos_f32 v243, v241
    v_sin_f32 v245, v241
    v_cvt_pk_bf16_f32 v39, v242, v243
    v_cvt_pk_bf16_f32 v55, v244, v245
    v_xor_b32 v47, 0x80008000, v55
    v_fmamk_f32 v240, v32, 0x3f000000, v33
    v_fmamk_f32 v241, v32, 0x3f080000, v33
    v_cos_f32 v242, v240
    v_sin_f32 v244, v240
    v_cos_f32 v243, v241
    v_sin_f32 v245, v241
    v_cvt_pk_bf16_f32 v40, v242, v243
    v_cvt_pk_bf16_f32 v56, v244, v245
    v_xor_b32 v48, 0x80008000, v56
    v_fmamk_f32 v240, v32, 0x3f100000, v33
    v_fmamk_f32 v241, v32, 0x3f180000, v33
    v_cos_f32 v242, v240
    v_sin_f32 v244, v240
    v_cos_f32 v243, v241
    v_sin_f32 v245, v241
    v_cvt_pk_bf16_f32 v41, v242, v243
    v_cvt_pk_bf16_f32 v57, v244, v245
    v_xor_b32 v49, 0x80008000, v57
    v_fmamk_f32 v240, v32, 0x3f400000, v33
    v_fmamk_f32 v241, v32, 0x3f480000, v33
    v_cos_f32 v242, v240
    v_sin_f32 v244, v240
    v_cos_f32 v243, v241
    v_sin_f32 v245, v241
    v_cvt_pk_bf16_f32 v42, v242, v243
    v_cvt_pk_bf16_f32 v58, v244, v245
    v_xor_b32 v50, 0x80008000, v58
    v_fmamk_f32 v240, v32, 0x3f500000, v33
    v_fmamk_f32 v241, v32, 0x3f580000, v33
    v_cos_f32 v242, v240
    v_sin_f32 v244, v240
    v_cos_f32 v243, v241
    v_sin_f32 v245, v241
    v_cvt_pk_bf16_f32 v43, v242, v243
    v_cvt_pk_bf16_f32 v59, v244, v245
    v_xor_b32 v51, 0x80008000, v59
    s_cmp_eq_u32 s8, 2
    s_cselect_b32 s22, s63, s8
    s_cselect_b32 s23, 4, s63
    s_cselect_b32 s24, s63, 0
    s_mul_i32 s24, s24, 40960
    s_lshl_b32 s25, s23, 6
    s_add_u32 s25, s25, s22
    v_lshl_add_u32 v240, v30, 1, s25
    v_cmp_eq_u32 vcc, 0, v240
    v_cvt_f32_u32 v240, v240
    v_mul_f32 v240, 0x3acccccd, v240
    v_mul_f32 v77, 0x41800000, v240
    v_mul_f32 v68, v34, v240
    v_mul_f32 v68, 0x41000000, v68
    v_cos_f32 v76, v77
    v_fmamk_f32 v69, v240, 0x3f800000, v68
    v_fmamk_f32 v70, v240, 0x40000000, v68
    v_fmamk_f32 v71, v240, 0x40400000, v68
    v_fmamk_f32 v72, v240, 0x40800000, v68
    v_fmamk_f32 v73, v240, 0x40a00000, v68
    v_fmamk_f32 v74, v240, 0x40c00000, v68
    v_fmamk_f32 v75, v240, 0x40e00000, v68
    v_sub_f32 v168, v68, v77
    v_sub_f32 v169, v69, v77
    v_sub_f32 v170, v70, v77
    v_sub_f32 v171, v71, v77
    v_sub_f32 v172, v72, v77
    v_sub_f32 v173, v73, v77
    v_sub_f32 v174, v74, v77
    v_sub_f32 v175, v75, v77
    v_add_f32 v76, v76, v76
    v_cos_f32 v60, v68
    v_cos_f32 v61, v69
    v_cos_f32 v62, v70
    v_cos_f32 v63, v71
    v_cos_f32 v64, v72
    v_cos_f32 v65, v73
    v_cos_f32 v66, v74
    v_cos_f32_e64 v67, v75
    v_sin_f32_e64 v68, -v68
    v_sin_f32_e64 v69, -v69
    v_sin_f32_e64 v70, -v70
    v_sin_f32_e64 v71, -v71
    v_sin_f32_e64 v72, -v72
    v_sin_f32_e64 v73, -v73
    v_sin_f32_e64 v74, -v74
    v_sin_f32_e64 v75, -v75
    v_cndmask_b32_e64 v68, v68, 1.0, vcc
    v_cndmask_b32_e64 v69, v69, -1.0, vcc
    v_cndmask_b32_e64 v70, v70, 1.0, vcc
    v_cndmask_b32_e64 v71, v71, -1.0, vcc
    v_cndmask_b32_e64 v72, v72, 1.0, vcc
    v_cndmask_b32_e64 v73, v73, -1.0, vcc
    v_cndmask_b32_e64 v74, v74, 1.0, vcc
    v_cndmask_b32_e64 v75, v75, -1.0, vcc
    v_cos_f32 v160, v168
    v_cos_f32 v161, v169
    v_cos_f32 v162, v170
    v_cos_f32 v163, v171
    v_cos_f32 v164, v172
    v_cos_f32 v165, v173
    v_cos_f32 v166, v174
    v_cos_f32 v167, v175
    v_sin_f32_e64 v168, -v168
    v_sin_f32_e64 v169, -v169
    v_sin_f32_e64 v170, -v170
    v_sin_f32_e64 v171, -v171
    v_sin_f32_e64 v172, -v172
    v_sin_f32_e64 v173, -v173
    v_sin_f32_e64 v174, -v174
    v_sin_f32_e64 v175, -v175
    v_cndmask_b32_e64 v168, v168, 1.0, vcc
    v_cndmask_b32_e64 v169, v169, -1.0, vcc
    v_cndmask_b32_e64 v170, v170, 1.0, vcc
    v_cndmask_b32_e64 v171, v171, -1.0, vcc
    v_cndmask_b32_e64 v172, v172, 1.0, vcc
    v_cndmask_b32_e64 v173, v173, -1.0, vcc
    v_cndmask_b32_e64 v174, v174, 1.0, vcc
    v_cndmask_b32_e64 v175, v175, -1.0, vcc
    v_cvt_pk_bf16_f32 v78, v60, v61
    v_cvt_pk_bf16_f32 v82, v68, v69
    v_cvt_pk_bf16_f32 v79, v62, v63
    v_cvt_pk_bf16_f32 v83, v70, v71
    v_cvt_pk_bf16_f32 v80, v64, v65
    v_cvt_pk_bf16_f32 v84, v72, v73
    v_cvt_pk_bf16_f32 v81, v66, v67
    v_cvt_pk_bf16_f32 v85, v74, v75
    v_mov_b64 v[176:177], 0
    v_mov_b64 v[178:179], 0
    v_mov_b64 v[180:181], 0
    v_mov_b64 v[182:183], 0
    v_mov_b64 v[184:185], 0
    v_mov_b64 v[186:187], 0
    v_mov_b64 v[188:189], 0
    v_mov_b64 v[190:191], 0
    v_mov_b64 v[192:193], 0
    v_mov_b64 v[194:195], 0
    v_mov_b64 v[196:197], 0
    v_mov_b64 v[198:199], 0
    v_mov_b64 v[200:201], 0
    v_mov_b64 v[202:203], 0
    v_mov_b64 v[204:205], 0
    v_mov_b64 v[206:207], 0
    v_mov_b64 v[208:209], 0
    v_mov_b64 v[210:211], 0
    v_mov_b64 v[212:213], 0
    v_mov_b64 v[214:215], 0
    v_mov_b64 v[216:217], 0
    v_mov_b64 v[218:219], 0
    v_mov_b64 v[220:221], 0
    v_mov_b64 v[222:223], 0
    v_mov_b64 v[224:225], 0
    v_mov_b64 v[226:227], 0
    v_mov_b64 v[228:229], 0
    v_mov_b64 v[230:231], 0
    v_mov_b64 v[232:233], 0
    v_mov_b64 v[234:235], 0
    v_mov_b64 v[236:237], 0
    v_mov_b64 v[238:239], 0
    v_lshrrev_b32_e64 v32, 3, v30
    v_mul_u32_u24 v32, 5120, v32
    v_lshl_add_u32 v32, v10, 7, v32
    v_bfe_u32 v33, v0, 1, 3
    v_xor_b32 v33, v33, v31
    v_lshl_add_u32 v32, v33, 4, v32
    v_xor_b32 v24, 0, v32
    v_add_u32 v24, s24, v24
    v_xor_b32 v25, 32, v32
    v_add_u32 v25, s24, v25
    v_xor_b32 v26, 64, v32
    v_add_u32_e64 v26, s24, v26
    v_add_u32 v26, 2048, v26
    v_xor_b32 v27, 96, v32
    v_add_u32_e64 v27, s24, v27
    v_add_u32 v27, 2048, v27
    v_mul_u32_u24 v33, 393216, v31
    v_lshl_add_u32 v28, v30, 3, v33
    v_add_u32 v33, 1280, v33
    v_mov_b32 v34, 0x80000000
    v_cndmask_b32_e64 v35, -1, 0, vcc
    v_add_u32 v33, 1280, v28
    v_cmp_gt_u32 vcc, 16, v30
    s_nop 1
    v_cndmask_b32_e64 v29, v34, v33, vcc
    buffer_load_dwordx4 v[96:99], v2, s[40:43], s75 offen offset:0
    buffer_load_dwordx4 v[100:103], v2, s[40:43], s75 offen offset:640
    buffer_load_dwordx4 v[104:107], v2, s[40:43], s75 offen offset:128
    buffer_load_dwordx4 v[108:111], v2, s[40:43], s75 offen offset:768
    buffer_load_dwordx4 v[112:115], v2, s[40:43], s75 offen offset:256
    buffer_load_dwordx4 v[116:119], v2, s[40:43], s75 offen offset:896
    buffer_load_dwordx4 v[120:123], v2, s[40:43], s75 offen offset:384
    buffer_load_dwordx4 v[124:127], v2, s[40:43], s75 offen offset:1024
    buffer_load_dwordx4 v[128:131], v2, s[40:43], s75 offen offset:512
    buffer_load_dwordx4 v[132:135], v2, s[40:43], s75 offen offset:1152
L_fold:
    v_mov_b32 v14, 0x80000000
    s_cmp_lg_u32 s14, s8
    s_cbranch_scc1 L_fold_go
    v_lshl_add_u32 v14, v10, 4, s15
    s_waitcnt vmcnt(10)
    ds_read_b128 v[136:139], v14 offset:0
    ds_read_b128 v[140:143], v14 offset:128
    ds_read_b128 v[144:147], v14 offset:256
    ds_read_b128 v[148:151], v14 offset:384
    ds_read_b128 v[152:155], v14 offset:512
    ds_read_b128 v[156:159], v14 offset:640
    ds_read_b128 v[160:163], v14 offset:768
    ds_read_b128 v[164:167], v14 offset:896
    ds_read_b128 v[168:171], v14 offset:1024
    ds_read_b128 v[172:175], v14 offset:1152
    v_mov_b32 v40, 0
    v_mov_b32 v41, 0
    v_mov_b32 v42, 0
    v_mov_b32 v43, 0
    s_lshl2_add_u32 s64, s62, s63
    s_lshl_b32 s64, s64, 7
    s_add_u32 s64, s64, 5767168
    v_lshl_add_u32 v14, v8, 2, v10
    v_lshl_add_u32 v14, v14, 2, s64
    v_mov_b32 v15, 0x80000000
    v_cmp_gt_u32 vcc, 4, v10
    s_nop 1
    v_cndmask_b32 v14, v15, v14, vcc
    s_waitcnt lgkmcnt(0)
L_fold_go:
    v_mov_b32 v15, s11
    s_cmp_eq_u32 s8, 2
    s_cbranch_scc1 L_fold2
    s_waitcnt vmcnt(8)
    v_perm_b32 v240, v100, v96, s12
    v_perm_b32 v241, v100, v96, s13
    v_perm_b32 v242, v101, v97, s12
    v_perm_b32 v243, v101, v97, s13
    v_perm_b32 v244, v102, v98, s12
    v_perm_b32 v245, v102, v98, s13
    v_perm_b32 v246, v103, v99, s12
    v_perm_b32 v247, v103, v99, s13
    v_dot2_f32_bf16 v240, v240, v15, 0
    v_dot2_f32_bf16 v241, v241, v15, 0
    v_dot2_f32_bf16 v242, v242, v15, 0
    v_dot2_f32_bf16 v243, v243, v15, 0
    v_dot2_f32_bf16 v244, v244, v15, 0
    v_dot2_f32_bf16 v245, v245, v15, 0
    v_dot2_f32_bf16 v246, v246, v15, 0
    v_dot2_f32_bf16 v247, v247, v15, 0
    v_cvt_pk_bf16_f32 v4, v240, v241
    v_cvt_pk_bf16_f32 v5, v242, v243
    v_cvt_pk_bf16_f32 v6, v244, v245
    v_cvt_pk_bf16_f32 v7, v246, v247
    ds_write_b128 v3, v[4:7] offset:0
    s_cmp_lg_u32 s14, s8
    s_cbranch_scc1 L_nod0
    v_dot2c_f32_bf16 v40, v96, v136
    v_dot2c_f32_bf16 v41, v97, v137
    v_dot2c_f32_bf16 v42, v98, v138
    v_dot2c_f32_bf16 v43, v99, v139
    v_dot2c_f32_bf16 v40, v100, v156
    v_dot2c_f32_bf16 v41, v101, v157
    v_dot2c_f32_bf16 v42, v102, v158
    v_dot2c_f32_bf16 v43, v103, v159
L_nod0:
    s_waitcnt vmcnt(6)
    v_perm_b32 v240, v108, v104, s12
    v_perm_b32 v241, v108, v104, s13
    v_perm_b32 v242, v109, v105, s12
    v_perm_b32 v243, v109, v105, s13
    v_perm_b32 v244, v110, v106, s12
    v_perm_b32 v245, v110, v106, s13
    v_perm_b32 v246, v111, v107, s12
    v_perm_b32 v247, v111, v107, s13
    v_dot2_f32_bf16 v240, v240, v15, 0
    v_dot2_f32_bf16 v241, v241, v15, 0
    v_dot2_f32_bf16 v242, v242, v15, 0
    v_dot2_f32_bf16 v243, v243, v15, 0
    v_dot2_f32_bf16 v244, v244, v15, 0
    v_dot2_f32_bf16 v245, v245, v15, 0
    v_dot2_f32_bf16 v246, v246, v15, 0
    v_dot2_f32_bf16 v247, v247, v15, 0
    v_cvt_pk_bf16_f32 v20, v240, v241
    v_cvt_pk_bf16_f32 v21, v242, v243
    v_cvt_pk_bf16_f32 v22, v244, v245
    v_cvt_pk_bf16_f32 v23, v246, v247
    ds_write_b128 v3, v[20:23] offset:1024
    s_cbranch_scc1 L_nod1
    v_dot2c_f32_bf16 v40, v104, v140
    v_dot2c_f32_bf16 v41, v105, v141
    v_dot2c_f32_bf16 v42, v106, v142
    v_dot2c_f32_bf16 v43, v107, v143
    v_dot2c_f32_bf16 v40, v108, v160
    v_dot2c_f32_bf16 v41, v109, v161
    v_dot2c_f32_bf16 v42, v110, v162
    v_dot2c_f32_bf16 v43, v111, v163
L_nod1:
    s_waitcnt vmcnt(4)
    v_perm_b32 v240, v116, v112, s12
    v_perm_b32 v241, v116, v112, s13
    v_perm_b32 v242, v117, v113, s12
    v_perm_b32 v243, v117, v113, s13
    v_perm_b32 v244, v118, v114, s12
    v_perm_b32 v245, v118, v114, s13
    v_perm_b32 v246, v119, v115, s12
    v_perm_b32 v247, v119, v115, s13
    v_dot2_f32_bf16 v240, v240, v15, 0
    v_dot2_f32_bf16 v241, v241, v15, 0
    v_dot2_f32_bf16 v242, v242, v15, 0
    v_dot2_f32_bf16 v243, v243, v15, 0
    v_dot2_f32_bf16 v244, v244, v15, 0
    v_dot2_f32_bf16 v245, v245, v15, 0
    v_dot2_f32_bf16 v246, v246, v15, 0
    v_dot2_f32_bf16 v247, v247, v15, 0
    v_cvt_pk_bf16_f32 v4, v240, v241
    v_cvt_pk_bf16_f32 v5, v242, v243
    v_cvt_pk_bf16_f32 v6, v244, v245
    v_cvt_pk_bf16_f32 v7, v246, v247
    ds_write_b128 v3, v[4:7] offset:2048
    s_cbranch_scc1 L_nod2
    v_dot2c_f32_bf16 v40, v112, v144
    v_dot2c_f32_bf16 v41, v113, v145
    v_dot2c_f32_bf16 v42, v114, v146
    v_dot2c_f32_bf16 v43, v115, v147
    v_dot2c_f32_bf16 v40, v116, v164
    v_dot2c_f32_bf16 v41, v117, v165
    v_dot2c_f32_bf16 v42, v118, v166
    v_dot2c_f32_bf16 v43, v119, v167
L_nod2:
    s_waitcnt vmcnt(2)
    v_perm_b32 v240, v124, v120, s12
    v_perm_b32 v241, v124, v120, s13
    v_perm_b32 v242, v125, v121, s12
    v_perm_b32 v243, v125, v121, s13
    v_perm_b32 v244, v126, v122, s12
    v_perm_b32 v245, v126, v122, s13
    v_perm_b32 v246, v127, v123, s12
    v_perm_b32 v247, v127, v123, s13
    v_dot2_f32_bf16 v240, v240, v15, 0
    v_dot2_f32_bf16 v241, v241, v15, 0
    v_dot2_f32_bf16 v242, v242, v15, 0
    v_dot2_f32_bf16 v243, v243, v15, 0
    v_dot2_f32_bf16 v244, v244, v15, 0
    v_dot2_f32_bf16 v245, v245, v15, 0
    v_dot2_f32_bf16 v246, v246, v15, 0
    v_dot2_f32_bf16 v247, v247, v15, 0
    v_cvt_pk_bf16_f32 v20, v240, v241
    v_cvt_pk_bf16_f32 v21, v242, v243
    v_cvt_pk_bf16_f32 v22, v244, v245
    v_cvt_pk_bf16_f32 v23, v246, v247
    ds_write_b128 v3, v[20:23] offset:3072
    s_cbranch_scc1 L_nod3
    v_dot2c_f32_bf16 v40, v120, v148
    v_dot2c_f32_bf16 v41, v121, v149
    v_dot2c_f32_bf16 v42, v122, v150
    v_dot2c_f32_bf16 v43, v123, v151
    v_dot2c_f32_bf16 v40, v124, v168
    v_dot2c_f32_bf16 v41, v125, v169
    v_dot2c_f32_bf16 v42, v126, v170
    v_dot2c_f32_bf16 v43, v127, v171
L_nod3:
    s_waitcnt vmcnt(0)
    v_perm_b32 v240, v132, v128, s12
    v_perm_b32 v241, v132, v128, s13
    v_perm_b32 v242, v133, v129, s12
    v_perm_b32 v243, v133, v129, s13
    v_perm_b32 v244, v134, v130, s12
    v_perm_b32 v245, v134, v130, s13
    v_perm_b32 v246, v135, v131, s12
    v_perm_b32 v247, v135, v131, s13
    v_dot2_f32_bf16 v240, v240, v15, 0
    v_dot2_f32_bf16 v241, v241, v15, 0
    v_dot2_f32_bf16 v242, v242, v15, 0
    v_dot2_f32_bf16 v243, v243, v15, 0
    v_dot2_f32_bf16 v244, v244, v15, 0
    v_dot2_f32_bf16 v245, v245, v15, 0
    v_dot2_f32_bf16 v246, v246, v15, 0
    v_dot2_f32_bf16 v247, v247, v15, 0
    v_cvt_pk_bf16_f32 v4, v240, v241
    v_cvt_pk_bf16_f32 v5, v242, v243
    v_cvt_pk_bf16_f32 v6, v244, v245
    v_cvt_pk_bf16_f32 v7, v246, v247
    ds_write_b128 v3, v[4:7] offset:4096
    s_cbranch_scc1 L_nod4
    v_dot2c_f32_bf16 v40, v128, v152
    v_dot2c_f32_bf16 v41, v129, v153
    v_dot2c_f32_bf16 v42, v130, v154
    v_dot2c_f32_bf16 v43, v131, v155
    v_dot2c_f32_bf16 v40, v132, v172
    v_dot2c_f32_bf16 v41, v133, v173
    v_dot2c_f32_bf16 v42, v134, v174
    v_dot2c_f32_bf16 v43, v135, v175
L_nod4:
    s_branch L_fold_done
L_fold2:
    v_mov_b32 v14, 0xbf803f80
    s_waitcnt vmcnt(8)
    v_perm_b32 v240, v100, v96, s12
    v_perm_b32 v241, v100, v96, s13
    v_perm_b32 v242, v101, v97, s12
    v_perm_b32 v243, v101, v97, s13
    v_perm_b32 v244, v102, v98, s12
    v_perm_b32 v245, v102, v98, s13
    v_perm_b32 v246, v103, v99, s12
    v_perm_b32 v247, v103, v99, s13
    v_dot2_f32_bf16 v96, v240, v14, 0
    v_dot2_f32_bf16 v97, v241, v14, 0
    v_dot2_f32_bf16 v98, v242, v14, 0
    v_dot2_f32_bf16 v99, v243, v14, 0
    v_dot2_f32_bf16 v100, v244, v14, 0
    v_dot2_f32_bf16 v101, v245, v14, 0
    v_dot2_f32_bf16 v102, v246, v14, 0
    v_dot2_f32_bf16 v103, v247, v14, 0
    v_dot2_f32_bf16 v240, v240, v15, 0
    v_dot2_f32_bf16 v241, v241, v15, 0
    v_dot2_f32_bf16 v242, v242, v15, 0
    v_dot2_f32_bf16 v243, v243, v15, 0
    v_dot2_f32_bf16 v244, v244, v15, 0
    v_dot2_f32_bf16 v245, v245, v15, 0
    v_dot2_f32_bf16 v246, v246, v15, 0
    v_dot2_f32_bf16 v247, v247, v15, 0
    v_cvt_pk_bf16_f32 v20, v96, v97
    v_cvt_pk_bf16_f32 v21, v98, v99
    v_cvt_pk_bf16_f32 v22, v100, v101
    v_cvt_pk_bf16_f32 v23, v102, v103
    ds_write_b128 v3, v[20:23] offset:40960
    v_cvt_pk_bf16_f32 v4, v240, v241
    v_cvt_pk_bf16_f32 v5, v242, v243
    v_cvt_pk_bf16_f32 v6, v244, v245
    v_cvt_pk_bf16_f32 v7, v246, v247
    ds_write_b128 v3, v[4:7] offset:0
    s_waitcnt vmcnt(6)
    v_perm_b32 v240, v108, v104, s12
    v_perm_b32 v241, v108, v104, s13
    v_perm_b32 v242, v109, v105, s12
    v_perm_b32 v243, v109, v105, s13
    v_perm_b32 v244, v110, v106, s12
    v_perm_b32 v245, v110, v106, s13
    v_perm_b32 v246, v111, v107, s12
    v_perm_b32 v247, v111, v107, s13
    v_dot2_f32_bf16 v104, v240, v14, 0
    v_dot2_f32_bf16 v105, v241, v14, 0
    v_dot2_f32_bf16 v106, v242, v14, 0
    v_dot2_f32_bf16 v107, v243, v14, 0
    v_dot2_f32_bf16 v108, v244, v14, 0
    v_dot2_f32_bf16 v109, v245, v14, 0
    v_dot2_f32_bf16 v110, v246, v14, 0
    v_dot2_f32_bf16 v111, v247, v14, 0
    v_dot2_f32_bf16 v240, v240, v15, 0
    v_dot2_f32_bf16 v241, v241, v15, 0
    v_dot2_f32_bf16 v242, v242, v15, 0
    v_dot2_f32_bf16 v243, v243, v15, 0
    v_dot2_f32_bf16 v244, v244, v15, 0
    v_dot2_f32_bf16 v245, v245, v15, 0
    v_dot2_f32_bf16 v246, v246, v15, 0
    v_dot2_f32_bf16 v247, v247, v15, 0
    v_cvt_pk_bf16_f32 v20, v104, v105
    v_cvt_pk_bf16_f32 v21, v106, v107
    v_cvt_pk_bf16_f32 v22, v108, v109
    v_cvt_pk_bf16_f32 v23, v110, v111
    ds_write_b128 v3, v[20:23] offset:41984
    v_cvt_pk_bf16_f32 v4, v240, v241
    v_cvt_pk_bf16_f32 v5, v242, v243
    v_cvt_pk_bf16_f32 v6, v244, v245
    v_cvt_pk_bf16_f32 v7, v246, v247
    ds_write_b128 v3, v[4:7] offset:1024
    s_waitcnt vmcnt(4)
    v_perm_b32 v240, v116, v112, s12
    v_perm_b32 v241, v116, v112, s13
    v_perm_b32 v242, v117, v113, s12
    v_perm_b32 v243, v117, v113, s13
    v_perm_b32 v244, v118, v114, s12
    v_perm_b32 v245, v118, v114, s13
    v_perm_b32 v246, v119, v115, s12
    v_perm_b32 v247, v119, v115, s13
    v_dot2_f32_bf16 v112, v240, v14, 0
    v_dot2_f32_bf16 v113, v241, v14, 0
    v_dot2_f32_bf16 v114, v242, v14, 0
    v_dot2_f32_bf16 v115, v243, v14, 0
    v_dot2_f32_bf16 v116, v244, v14, 0
    v_dot2_f32_bf16 v117, v245, v14, 0
    v_dot2_f32_bf16 v118, v246, v14, 0
    v_dot2_f32_bf16 v119, v247, v14, 0
    v_dot2_f32_bf16 v240, v240, v15, 0
    v_dot2_f32_bf16 v241, v241, v15, 0
    v_dot2_f32_bf16 v242, v242, v15, 0
    v_dot2_f32_bf16 v243, v243, v15, 0
    v_dot2_f32_bf16 v244, v244, v15, 0
    v_dot2_f32_bf16 v245, v245, v15, 0
    v_dot2_f32_bf16 v246, v246, v15, 0
    v_dot2_f32_bf16 v247, v247, v15, 0
    v_cvt_pk_bf16_f32 v20, v112, v113
    v_cvt_pk_bf16_f32 v21, v114, v115
    v_cvt_pk_bf16_f32 v22, v116, v117
    v_cvt_pk_bf16_f32 v23, v118, v119
    ds_write_b128 v3, v[20:23] offset:43008
    v_cvt_pk_bf16_f32 v4, v240, v241
    v_cvt_pk_bf16_f32 v5, v242, v243
    v_cvt_pk_bf16_f32 v6, v244, v245
    v_cvt_pk_bf16_f32 v7, v246, v247
    ds_write_b128 v3, v[4:7] offset:2048
    s_waitcnt vmcnt(2)
    v_perm_b32 v240, v124, v120, s12
    v_perm_b32 v241, v124, v120, s13
    v_perm_b32 v242, v125, v121, s12
    v_perm_b32 v243, v125, v121, s13
    v_perm_b32 v244, v126, v122, s12
    v_perm_b32 v245, v126, v122, s13
    v_perm_b32 v246, v127, v123, s12
    v_perm_b32 v247, v127, v123, s13
    v_dot2_f32_bf16 v120, v240, v14, 0
    v_dot2_f32_bf16 v121, v241, v14, 0
    v_dot2_f32_bf16 v122, v242, v14, 0
    v_dot2_f32_bf16 v123, v243, v14, 0
    v_dot2_f32_bf16 v124, v244, v14, 0
    v_dot2_f32_bf16 v125, v245, v14, 0
    v_dot2_f32_bf16 v126, v246, v14, 0
    v_dot2_f32_bf16 v127, v247, v14, 0
    v_dot2_f32_bf16 v240, v240, v15, 0
    v_dot2_f32_bf16 v241, v241, v15, 0
    v_dot2_f32_bf16 v242, v242, v15, 0
    v_dot2_f32_bf16 v243, v243, v15, 0
    v_dot2_f32_bf16 v244, v244, v15, 0
    v_dot2_f32_bf16 v245, v245, v15, 0
    v_dot2_f32_bf16 v246, v246, v15, 0
    v_dot2_f32_bf16 v247, v247, v15, 0
    v_cvt_pk_bf16_f32 v20, v120, v121
    v_cvt_pk_bf16_f32 v21, v122, v123
    v_cvt_pk_bf16_f32 v22, v124, v125
    v_cvt_pk_bf16_f32 v23, v126, v127
    ds_write_b128 v3, v[20:23] offset:44032
    v_cvt_pk_bf16_f32 v4, v240, v241
    v_cvt_pk_bf16_f32 v5, v242, v243
    v_cvt_pk_bf16_f32 v6, v244, v245
    v_cvt_pk_bf16_f32 v7, v246, v247
    ds_write_b128 v3, v[4:7] offset:3072
    s_waitcnt vmcnt(0)
    v_perm_b32 v240, v132, v128, s12
    v_perm_b32 v241, v132, v128, s13
    v_perm_b32 v242, v133, v129, s12
    v_perm_b32 v243, v133, v129, s13
    v_perm_b32 v244, v134, v130, s12
    v_perm_b32 v245, v134, v130, s13
    v_perm_b32 v246, v135, v131, s12
    v_perm_b32 v247, v135, v131, s13
    v_dot2_f32_bf16 v128, v240, v14, 0
    v_dot2_f32_bf16 v129, v241, v14, 0
    v_dot2_f32_bf16 v130, v242, v14, 0
    v_dot2_f32_bf16 v131, v243, v14, 0
    v_dot2_f32_bf16 v132, v244, v14, 0
    v_dot2_f32_bf16 v133, v245, v14, 0
    v_dot2_f32_bf16 v134, v246, v14, 0
    v_dot2_f32_bf16 v135, v247, v14, 0
    v_dot2_f32_bf16 v240, v240, v15, 0
    v_dot2_f32_bf16 v241, v241, v15, 0
    v_dot2_f32_bf16 v242, v242, v15, 0
    v_dot2_f32_bf16 v243, v243, v15, 0
    v_dot2_f32_bf16 v244, v244, v15, 0
    v_dot2_f32_bf16 v245, v245, v15, 0
    v_dot2_f32_bf16 v246, v246, v15, 0
    v_dot2_f32_bf16 v247, v247, v15, 0
    v_cvt_pk_bf16_f32 v20, v128, v129
    v_cvt_pk_bf16_f32 v21, v130, v131
    v_cvt_pk_bf16_f32 v22, v132, v133
    v_cvt_pk_bf16_f32 v23, v134, v135
    ds_write_b128 v3, v[20:23] offset:45056
    v_cvt_pk_bf16_f32 v4, v240, v241
    v_cvt_pk_bf16_f32 v5, v242, v243
    v_cvt_pk_bf16_f32 v6, v244, v245
    v_cvt_pk_bf16_f32 v7, v246, v247
    ds_write_b128 v3, v[4:7] offset:4096
    v_mov_b32 v14, 0x80000000
L_fold_done:
    s_mov_b64 exec, 1
    ds_add_u32 v17, v1 offset:24
    s_mov_b64 exec, -1
    s_cmp_ge_u32 s3, 4
    s_cbranch_scc1 L_dc
    s_waitcnt lgkmcnt(0)
    v_mov_b32 v201, s18
    v_mov_b32 v202, s19
    v_and_b32 v203, 1, v0
    v_cmp_eq_u32 vcc, 1, v203
    s_nop 1
    v_cndmask_b32 v201, v201, v202, vcc
    v_add_u32 v201, 1, v201
    s_setprio 3
    s_cmp_ge_u32 s3, 2
    s_cbranch_scc1 L_side23
    buffer_load_dword v33, v30, s[48:51], s67 offen
    s_add_u32 s67, s67, s68
    s_waitcnt vmcnt(1)
    buffer_load_dword v33, v30, s[48:51], s67 offen
    s_add_u32 s67, s67, s68
    s_waitcnt vmcnt(1)
    buffer_load_dword v33, v30, s[48:51], s67 offen
    s_add_u32 s67, s67, s68
    s_waitcnt vmcnt(1)
    buffer_load_dword v33, v30, s[48:51], s67 offen
    s_add_u32 s67, s67, s68
    s_waitcnt vmcnt(1)
    buffer_load_dword v33, v30, s[48:51], s67 offen
    s_add_u32 s67, s67, s68
    ds_write_b32 v17, v17 offset:20
    s_call_b64 s[60:61], L_gate
    s_branch L_sidedone
L_side23:
    s_sub_u32 s70, s3, 2
    s_mul_i32 s70, s70, 96
    s_add_u32 s70, s70, s6
    s_cmp_ge_u32 s70, 160
    s_cselect_b32 s74, 0, 1
    v_mov_b32 v27, 0
    s_cbranch_scc1 L_nopack0
    s_mov_b64 s[44:45], s[30:31]
    s_mov_b32 s46, 0xc8000
    s_mov_b32 s47, 0x20000
    s_and_b32 s71, s70, 7
    s_lshr_b32 s70, s70, 3
    s_mul_i32 s64, s70, 256
    s_add_u32 s64, s64, s71
    s_mul_i32 s64, s64, 160
    s_mul_i32 s65, s3, 5120
    s_add_u32 s65, s65, 81920
    v_mul_u32_u24 v24, 52, v0
    v_lshrrev_b32 v24, 9, v24
    v_mul_u32_u24 v24, 1120, v24
    v_add_u32 v24, v24, v13
    s_mov_b32 exec_hi, 0xff
    s_add_u32 m0, s65, 0
    s_add_u32 s66, s64, 0
    buffer_load_dwordx4 v24, s[44:47], s66 offen lds
    s_add_u32 m0, s65, 640
    s_add_u32 s66, s64, 10240
    buffer_load_dwordx4 v24, s[44:47], s66 offen lds
    s_add_u32 m0, s65, 1280
    s_add_u32 s66, s64, 5120
    buffer_load_dwordx4 v24, s[44:47], s66 offen lds
    s_add_u32 m0, s65, 1920
    s_add_u32 s66, s64, 15360
    buffer_load_dwordx4 v24, s[44:47], s66 offen lds
    s_add_u32 m0, s65, 2560
    s_add_u32 s66, s64, 20480
    buffer_load_dwordx4 v24, s[44:47], s66 offen lds
    s_add_u32 m0, s65, 3200
    s_add_u32 s66, s64, 30720
    buffer_load_dwordx4 v24, s[44:47], s66 offen lds
    s_add_u32 m0, s65, 3840
    s_add_u32 s66, s64, 25600
    buffer_load_dwordx4 v24, s[44:47], s66 offen lds
    s_add_u32 m0, s65, 4480
    s_add_u32 s66, s64, 35840
    buffer_load_dwordx4 v24, s[44:47], s66 offen lds
    s_mov_b32 exec_hi, -1
    v_lshrrev_b32_e64 v25, 5, v0
    v_bfe_u32 v26, v0, 2, 3
    v_lshl_add_u32 v25, v25, 4, v26
    v_mul_u32_u24 v25, 160, v25
    v_and_b32 v26, 3, v0
    v_lshl_add_u32 v25, v26, 3, v25
    v_add_u32 v27, s65, v25
    s_mul_i32 s71, s71, 20
    s_add_u32 s71, s71, s70
    s_mul_i32 s71, s71, 5120
    s_add_u32 s71, s71, 6063104
    s_add_u32 s70, s71, 4096
L_nopack0:
    s_call_b64 s[60:61], L_gate
    s_cmp_eq_u32 s74, 0
    s_cbranch_scc1 L_nopack
    s_waitcnt vmcnt(1)
    ds_read_b64_tr_b16 v[180:181], v27 offset:0
    ds_read_b64_tr_b16 v[182:183], v27 offset:1280
    ds_read_b64_tr_b16 v[184:185], v27 offset:32
    ds_read_b64_tr_b16 v[186:187], v27 offset:1312
    ds_read_b64_tr_b16 v[188:189], v27 offset:64
    ds_read_b64_tr_b16 v[190:191], v27 offset:1344
    ds_read_b64_tr_b16 v[192:193], v27 offset:96
    ds_read_b64_tr_b16 v[194:195], v27 offset:1376
    ds_read_b64_tr_b16 v[196:197], v27 offset:128
    ds_read_b64_tr_b16 v[198:199], v27 offset:1408
    s_waitcnt lgkmcnt(0)
    buffer_store_dwordx4 v[180:183], v13, s[52:55], s71 offen offset:0 sc1
    buffer_store_dwordx4 v[184:187], v13, s[52:55], s71 offen offset:1024 sc1
    buffer_store_dwordx4 v[188:191], v13, s[52:55], s71 offen offset:2048 sc1
    buffer_store_dwordx4 v[192:195], v13, s[52:55], s71 offen offset:3072 sc1
    buffer_store_dwordx4 v[196:199], v13, s[52:55], s70 offen sc1
L_nopack:
    s_lshr_b32 s64, s6, 2
    s_lshl_b32 s64, s64, 7
    s_and_b32 s65, s6, 3
    s_lshl2_add_u32 s64, s65, s64
    s_add_u32 s64, s64, 5812224
    v_lshl_add_u32 v204, v0, 15, s64
    s_mov_b64 exec, 1
    s_waitcnt vmcnt(0)
    ds_add_rtn_u32 v205, v17, v1 offset:8
    s_waitcnt lgkmcnt(0)
    v_readfirstlane_b32 s64, v205
    s_mov_b64 exec, 0xff
    s_nop 0
    s_cmp_lg_u32 s64, 1
    s_cbranch_scc1 L_noe2
    buffer_store_dword v201, v204, s[52:55], 0 offen sc0 sc1
L_noe2:
    s_mov_b64 exec, -1
L_spin_cw:
    s_sleep 2
    ds_read_b32 v18, v17 offset:20
    s_waitcnt lgkmcnt(0)
    v_readfirstlane_b32 s64, v18
    s_nop 1
    s_cmp_eq_u32 s64, 0
    s_cbranch_scc1 L_spin_cw
    s_cmp_lg_u32 s8, 1
    s_cbranch_scc1 L_noztail
    s_lshl1_add_u32 s60, s7, s4
    s_and_b32 s61, s60, 0xfc
    s_add_u32 s60, s60, s61
    s_mul_i32 s60, s60, 1536
    s_sub_u32 s61, s3, 2
    s_mul_i32 s61, s61, 1572864
    s_add_u32 s60, s60, s61
    s_add_u32 s60, s60, 2628864
    v_mul_u32_u24 v24, 98176, v8
    v_add_u32 v24, v24, v13
    buffer_store_dwordx4 v[4:7], v24, s[52:55], s60 offen sc1
    s_add_u32 s60, s60, 786432
    buffer_store_dwordx4 v[4:7], v24, s[52:55], s60 offen sc1
L_noztail:
    s_mov_b64 s[44:45], s[38:39]
    s_mov_b32 s46, 0x280000
    s_mov_b32 s47, 0x20000
    s_lshl1_add_u32 s60, s6, s3
    s_sub_u32 s60, s60, 2
    s_mul_i32 s60, s60, 14336
    v_mov_b64 v[4:5], -1
    v_mov_b64_e64 v[6:7], -1
    buffer_store_dwordx4 v[4:7], v13, s[44:47], s60 offen offset:0 sc1
    buffer_store_dwordx4 v[4:7], v13, s[44:47], s60 offen offset:1024 sc1
    buffer_store_dwordx4 v[4:7], v13, s[44:47], s60 offen offset:2048 sc1
    buffer_store_dwordx4 v[4:7], v13, s[44:47], s60 offen offset:3072 sc1
    s_add_u32 s60, s60, 4096
    buffer_store_dwordx4 v[4:7], v13, s[44:47], s60 offen offset:0 sc1
    buffer_store_dwordx4 v[4:7], v13, s[44:47], s60 offen offset:1024 sc1
    buffer_store_dwordx4 v[4:7], v13, s[44:47], s60 offen offset:2048 sc1
    buffer_store_dwordx4 v[4:7], v13, s[44:47], s60 offen offset:3072 sc1
    s_add_u32 s60, s60, 4096
    buffer_store_dwordx4 v[4:7], v13, s[44:47], s60 offen offset:0 sc1
    buffer_store_dwordx4 v[4:7], v13, s[44:47], s60 offen offset:1024 sc1
    buffer_store_dwordx4 v[4:7], v13, s[44:47], s60 offen offset:2048 sc1
    buffer_store_dwordx4 v[4:7], v13, s[44:47], s60 offen offset:3072 sc1
    s_add_u32 s60, s60, 4096
    buffer_store_dwordx4 v[4:7], v13, s[44:47], s60 offen offset:0 sc1
    buffer_store_dwordx4 v[4:7], v13, s[44:47], s60 offen offset:1024 sc1
L_sidedone:
    s_lshl_b32 s64, s6, 7
    s_add_u32 s64, s64, 5799936
    v_lshl_add_u32 v200, v0, 15, s64
    s_bitcmp0_b32 s2, 0
    s_cselect_b32 s26, s18, s19
    s_add_u32 s26, s26, 1
    v_mov_b32 v202, 163008
    s_call_b64 s[60:61], L_arrive
    s_setprio 0
    s_call_b64 s[60:61], L_p2setup1
    s_call_b64 s[60:61], L_p2setup2
    s_call_b64 s[60:61], L_p2setup3
    s_call_b64 s[60:61], L_p2setup4
    s_cmp_lg_u32 s3, 0
    s_cbranch_scc1 L_nop4
    buffer_load_dwordx4 v[66:69], v74, s[52:55], s79 offen sc1
L_nop4:
    s_cmp_lg_u32 s3, 0
    s_cbranch_scc1 L_e2ok_d
    s_mov_b32 s66, 400000
    s_waitcnt vmcnt(0)
L_e2_d:
    v_xor_b32 v66, s26, v66
    v_xor_b32 v67, s26, v67
    v_xor_b32 v68, s26, v68
    v_xor_b32 v69, s26, v69
    v_or3_b32 v66, v66, v67, v68
    v_or_b32 v66, v66, v69
    v_cmp_ne_u32 vcc, 0, v66
    s_cbranch_vccz L_e2ok_d
    s_sleep 6
    buffer_load_dwordx4 v[66:69], v74, s[52:55], s79 offen sc1
    s_waitcnt vmcnt(0)
    s_sub_u32 s66, s66, 1
    s_cmp_lg_u32 s66, 0
    s_cbranch_scc1 L_e2_d
L_e2ok_d:
    s_barrier
    s_branch L_post9
L_gate:
    s_cmp_lg_u32 s14, s8
    s_cbranch_scc1 L_nogate
    v_add_f32 v40, v40, v41
    v_add_f32 v42, v42, v43
    v_add_f32 v40, v40, v42
    s_nop 1
    v_add_f32_dpp v40, v40, v40 quad_perm:[1,0,3,2] row_mask:0xf bank_mask:0xf
    s_nop 1
    v_add_f32_dpp v40, v40, v40 quad_perm:[2,3,0,1] row_mask:0xf bank_mask:0xf
    s_nop 1
    v_add_f32_dpp v40, v40, v40 row_half_mirror row_mask:0xf bank_mask:0xf
    v_mul_f32 v40, 0xbfb8aa3b, v40
    v_exp_f32 v40, v40
    s_nop 0
    v_add_f32 v40, 1.0, v40
    v_rcp_f32 v9, v40
L_nogate:
    s_nop 0
    buffer_store_dword v9, v14, s[52:55], 0 offen sc1
    s_setpc_b64 s[60:61]
L_arrive:
    s_lshl_b32 s64, s6, 7
    s_add_u32 s64, s64, 5799936
    v_lshrrev_b32 v207, 3, v0
    v_lshl_add_u32 v206, v207, 15, s64
    v_and_b32 v207, 7, v0
    v_lshl_add_u32 v206, v207, 4, v206
    v_mov_b32 v208, s18
    v_mov_b32 v209, s19
    v_and_b32 v207, 8, v0
    v_cmp_ne_u32 vcc, 0, v207
    s_nop 1
    v_cndmask_b32 v208, v208, v209, vcc
    v_add_u32 v208, 1, v208
    v_mov_b32 v209, v208
    v_mov_b32 v210, v208
    v_mov_b32 v211, v208
    s_mov_b64 exec, 1
    s_waitcnt vmcnt(0)
    ds_add_rtn_u32 v205, v202, v1 offset:28
    s_waitcnt lgkmcnt(0)
    v_readfirstlane_b32 s64, v205
    s_mov_b64 exec, -1
    s_nop 0
    s_cmp_lg_u32 s64, 7
    s_cbranch_scc1 L_arr1
    buffer_store_dwordx4 v[208:211], v206, s[52:55], 0 offen sc0 sc1
L_arr1:
    s_mov_b64 exec, -1
    s_setpc_b64 s[60:61]
L_dc:
L_spin_b0:
    ds_read_b32 v18, v16 offset:24
    s_waitcnt lgkmcnt(0)
    v_readfirstlane_b32 s64, v18
    s_nop 1
    s_cmp_ge_u32 s64, 8
    s_cbranch_scc0 L_spin_b0
    s_cmp_ge_u32 s22, 2
    s_cbranch_scc1 L_dc_end
    s_lshl_b32 s62, s7, 1
    s_add_u32 s62, s62, s4
    s_and_b32 s61, s62, 0xfc
    s_add_u32 s62, s62, s61
    s_lshl_b32 s61, s22, 2
    s_add_u32 s62, s62, s61
    s_mul_i32 s62, s62, 1536
    s_lshl_b32 s61, s23, 8
    s_add_u32 s62, s62, s61
    ds_read_b128 v[96:99], v24 offset:0
    ds_read_b128 v[100:103], v24 offset:20480
    ds_read_b128 v[104:107], v26 offset:0
    ds_read_b128 v[108:111], v26 offset:20480
    v_and_b32_e64 v249, 1, v0
    v_mul_u32_u24 v249, 0x8000, v249
    v_lshl_or_b32 v249, v249, 16, v249
    s_mul_i32 s61, s22, 0x80008000
    v_xor_b32_e64 v248, s61, v249
    s_add_u32 s64, s62, 2621440
    s_add_u32 s65, s62, 2719744
    s_add_u32 s66, s62, 2818048
    s_add_u32 s67, s62, 2916352
    s_add_u32 s68, s62, 3407872
    s_add_u32 s69, s62, 3506176
    s_add_u32 s70, s62, 3604480
    s_add_u32 s71, s62, 3702784
    s_add_u32 s72, s62, 4194304
    s_add_u32 s73, s62, 4292608
    s_add_u32 s74, s62, 4390912
    s_add_u32 s75, s62, 4489216
    s_add_u32 s76, s62, 4980736
    s_add_u32 s77, s62, 5079040
    s_add_u32 s78, s62, 5177344
    s_add_u32 s79, s62, 5275648
    s_mov_b32 s61, 5
    s_mov_b32 s62, 0
    s_movk_i32 s63, 1024
    s_cmp_lg_u32 s22, 0
    s_cbranch_scc1 L_dloop1
.p2align 3
L_dloop0:
    s_waitcnt lgkmcnt(0)
    s_sub_u32 s61, s61, 1
    v_mfma_f32_32x32x16_bf16 v[176:191], v[96:99], v[78:81], v[176:191]
    ds_read_b128 v[112:115], v25 offset:0
    ds_read_b128 v[116:119], v25 offset:20480
    ds_read_b128 v[120:123], v27 offset:0
    ds_read_b128 v[124:127], v27 offset:20480
    v_xor_b32_e64 v240, v248, v78
    v_mfma_f32_32x32x16_bf16 v[192:207], v[96:99], v[82:85], v[192:207]
    v_xor_b32_e64 v241, v248, v79
    v_xor_b32_e64 v242, v248, v80
    v_xor_b32_e64 v243, v248, v81
    v_xor_b32_e64 v244, v249, v82
    v_xor_b32_e64 v245, v249, v83
    v_mfma_f32_32x32x16_bf16 v[208:223], v[100:103], v[78:81], v[208:223]
    v_xor_b32_e64 v246, v249, v84
    v_xor_b32_e64 v247, v249, v85
    v_xad_u32 v24, v24, 64, s62
    v_xad_u32 v26, v26, 64, s63
    v_fma_f32 v160, v76, v60, -v160
    v_mfma_f32_32x32x16_bf16 v[224:239], v[100:103], v[82:85], v[224:239]
    v_fma_f32 v161, v76, v61, -v161
    v_fma_f32 v168, v76, v68, -v168
    v_fma_f32 v169, v76, v69, -v169
    v_cvt_pk_bf16_f32 v86, v160, v161
    v_cvt_pk_bf16_f32 v90, v168, v169
    v_mfma_f32_32x32x16_bf16 v[176:191], v[104:107], v[240:243], v[176:191]
    v_fma_f32 v162, v76, v62, -v162
    v_fma_f32 v163, v76, v63, -v163
    v_fma_f32 v170, v76, v70, -v170
    v_fma_f32 v171, v76, v71, -v171
    v_cvt_pk_bf16_f32 v87, v162, v163
    v_mfma_f32_32x32x16_bf16 v[192:207], v[104:107], v[244:247], v[192:207]
    v_cvt_pk_bf16_f32 v91, v170, v171
    v_fma_f32 v164, v76, v64, -v164
    v_fma_f32 v165, v76, v65, -v165
    v_fma_f32 v172, v76, v72, -v172
    v_fma_f32 v173, v76, v73, -v173
    v_mfma_f32_32x32x16_bf16 v[208:223], v[108:111], v[240:243], v[208:223]
    v_cvt_pk_bf16_f32 v88, v164, v165
    v_cvt_pk_bf16_f32 v92, v172, v173
    v_fma_f32 v166, v76, v66, -v166
    v_fma_f32 v167, v76, v67, -v167
    v_fma_f32 v174, v76, v74, -v174
    v_mfma_f32_32x32x16_bf16 v[224:239], v[108:111], v[244:247], v[224:239]
    v_fma_f32 v175, v76, v75, -v175
    v_cvt_pk_bf16_f32 v89, v166, v167
    v_cvt_pk_bf16_f32 v93, v174, v175
    s_waitcnt lgkmcnt(0)
    s_nop 0
    v_mfma_f32_32x32x16_bf16 v[176:191], v[112:115], v[86:89], v[176:191]
    ds_read_b128 v[96:99], v24 offset:0
    ds_read_b128 v[100:103], v24 offset:20480
    ds_read_b128 v[104:107], v26 offset:0
    ds_read_b128 v[108:111], v26 offset:20480
    v_xor_b32_e64 v240, v248, v86
    v_mfma_f32_32x32x16_bf16 v[192:207], v[112:115], v[90:93], v[192:207]
    v_xor_b32_e64 v241, v248, v87
    v_xor_b32_e64 v242, v248, v88
    v_xor_b32_e64 v243, v248, v89
    v_xor_b32_e64 v244, v249, v90
    v_xor_b32_e64 v245, v249, v91
    v_mfma_f32_32x32x16_bf16 v[208:223], v[116:119], v[86:89], v[208:223]
    v_xor_b32_e64 v246, v249, v92
    v_xor_b32_e64 v247, v249, v93
    v_xad_u32 v25, v25, 64, s62
    v_xad_u32 v27, v27, 64, s63
    v_fma_f32 v60, v76, v160, -v60
    v_mfma_f32_32x32x16_bf16 v[224:239], v[116:119], v[90:93], v[224:239]
    v_fma_f32 v61, v76, v161, -v61
    v_fma_f32 v68, v76, v168, -v68
    v_fma_f32 v69, v76, v169, -v69
    v_cvt_pk_bf16_f32 v78, v60, v61
    v_cvt_pk_bf16_f32 v82, v68, v69
    v_mfma_f32_32x32x16_bf16 v[176:191], v[120:123], v[240:243], v[176:191]
    v_fma_f32 v62, v76, v162, -v62
    v_fma_f32 v63, v76, v163, -v63
    v_fma_f32 v70, v76, v170, -v70
    v_fma_f32 v71, v76, v171, -v71
    v_cvt_pk_bf16_f32 v79, v62, v63
    v_mfma_f32_32x32x16_bf16 v[192:207], v[120:123], v[244:247], v[192:207]
    v_cvt_pk_bf16_f32 v83, v70, v71
    v_fma_f32 v64, v76, v164, -v64
    v_fma_f32 v65, v76, v165, -v65
    v_fma_f32 v72, v76, v172, -v72
    v_fma_f32 v73, v76, v173, -v73
    v_mfma_f32_32x32x16_bf16 v[208:223], v[124:127], v[240:243], v[208:223]
    v_cvt_pk_bf16_f32 v80, v64, v65
    v_cvt_pk_bf16_f32 v84, v72, v73
    v_fma_f32 v66, v76, v166, -v66
    v_fma_f32 v67, v76, v167, -v67
    v_fma_f32 v74, v76, v174, -v74
    v_mfma_f32_32x32x16_bf16 v[224:239], v[124:127], v[244:247], v[224:239]
    v_fma_f32 v75, v76, v175, -v75
    v_cvt_pk_bf16_f32 v81, v66, v67
    v_cvt_pk_bf16_f32 v85, v74, v75
    s_xor_b32 s62, s62, 1024
    s_xor_b32 s63, s63, 1024
    s_cmp_lg_u32 s61, 0
    s_cbranch_scc1 L_dloop0
    s_branch L_dloop_end
.p2align 3
L_dloop1:
    s_waitcnt lgkmcnt(0)
    s_sub_u32 s61, s61, 1
    v_mfma_f32_32x32x16_bf16 v[176:191], v[96:99], v[78:81], v[176:191]
    ds_read_b128 v[112:115], v25 offset:0
    ds_read_b128 v[116:119], v25 offset:20480
    ds_read_b128 v[120:123], v27 offset:0
    ds_read_b128 v[124:127], v27 offset:20480
    v_xor_b32_e64 v240, v248, v78
    v_mfma_f32_32x32x16_bf16 v[192:207], v[96:99], v[82:85], v[192:207]
    v_xor_b32_e64 v241, v248, v79
    v_xor_b32_e64 v242, v248, v80
    v_xor_b32_e64 v243, v248, v81
    v_xor_b32_e64 v244, v249, v82
    v_xor_b32_e64 v245, v249, v83
    v_mfma_f32_32x32x16_bf16 v[208:223], v[100:103], v[78:81], v[208:223]
    v_xor_b32_e64 v246, v249, v84
    v_xor_b32_e64 v247, v249, v85
    v_xad_u32 v24, v24, 64, s62
    v_xad_u32 v26, v26, 64, s63
    v_fma_f32 v160, v76, v60, -v160
    v_mfma_f32_32x32x16_bf16 v[224:239], v[100:103], v[82:85], v[224:239]
    v_fma_f32 v161, v76, v61, -v161
    v_fma_f32 v168, v76, v68, -v168
    v_fma_f32 v169, v76, v69, -v169
    v_cvt_pk_bf16_f32 v86, v160, v161
    v_cvt_pk_bf16_f32 v90, v168, v169
    v_mfma_f32_32x32x16_bf16 v[192:207], v[104:107], v[240:243], v[192:207]
    v_fma_f32 v162, v76, v62, -v162
    v_fma_f32 v163, v76, v63, -v163
    v_fma_f32 v170, v76, v70, -v170
    v_fma_f32 v171, v76, v71, -v171
    v_cvt_pk_bf16_f32 v87, v162, v163
    v_mfma_f32_32x32x16_bf16 v[176:191], v[104:107], v[244:247], v[176:191]
    v_cvt_pk_bf16_f32 v91, v170, v171
    v_fma_f32 v164, v76, v64, -v164
    v_fma_f32 v165, v76, v65, -v165
    v_fma_f32 v172, v76, v72, -v172
    v_fma_f32 v173, v76, v73, -v173
    v_mfma_f32_32x32x16_bf16 v[224:239], v[108:111], v[240:243], v[224:239]
    v_cvt_pk_bf16_f32 v88, v164, v165
    v_cvt_pk_bf16_f32 v92, v172, v173
    v_fma_f32 v166, v76, v66, -v166
    v_fma_f32 v167, v76, v67, -v167
    v_fma_f32 v174, v76, v74, -v174
    v_mfma_f32_32x32x16_bf16 v[208:223], v[108:111], v[244:247], v[208:223]
    v_fma_f32 v175, v76, v75, -v175
    v_cvt_pk_bf16_f32 v89, v166, v167
    v_cvt_pk_bf16_f32 v93, v174, v175
    s_waitcnt lgkmcnt(0)
    s_nop 0
    v_mfma_f32_32x32x16_bf16 v[176:191], v[112:115], v[86:89], v[176:191]
    ds_read_b128 v[96:99], v24 offset:0
    ds_read_b128 v[100:103], v24 offset:20480
    ds_read_b128 v[104:107], v26 offset:0
    ds_read_b128 v[108:111], v26 offset:20480
    v_xor_b32_e64 v240, v248, v86
    v_mfma_f32_32x32x16_bf16 v[192:207], v[112:115], v[90:93], v[192:207]
    v_xor_b32_e64 v241, v248, v87
    v_xor_b32_e64 v242, v248, v88
    v_xor_b32_e64 v243, v248, v89
    v_xor_b32_e64 v244, v249, v90
    v_xor_b32_e64 v245, v249, v91
    v_mfma_f32_32x32x16_bf16 v[208:223], v[116:119], v[86:89], v[208:223]
    v_xor_b32_e64 v246, v249, v92
    v_xor_b32_e64 v247, v249, v93
    v_xad_u32 v25, v25, 64, s62
    v_xad_u32 v27, v27, 64, s63
    v_fma_f32 v60, v76, v160, -v60
    v_mfma_f32_32x32x16_bf16 v[224:239], v[116:119], v[90:93], v[224:239]
    v_fma_f32 v61, v76, v161, -v61
    v_fma_f32 v68, v76, v168, -v68
    v_fma_f32 v69, v76, v169, -v69
    v_cvt_pk_bf16_f32 v78, v60, v61
    v_cvt_pk_bf16_f32 v82, v68, v69
    v_mfma_f32_32x32x16_bf16 v[192:207], v[120:123], v[240:243], v[192:207]
    v_fma_f32 v62, v76, v162, -v62
    v_fma_f32 v63, v76, v163, -v63
    v_fma_f32 v70, v76, v170, -v70
    v_fma_f32 v71, v76, v171, -v71
    v_cvt_pk_bf16_f32 v79, v62, v63
    v_mfma_f32_32x32x16_bf16 v[176:191], v[120:123], v[244:247], v[176:191]
    v_cvt_pk_bf16_f32 v83, v70, v71
    v_fma_f32 v64, v76, v164, -v64
    v_fma_f32 v65, v76, v165, -v65
    v_fma_f32 v72, v76, v172, -v72
    v_fma_f32 v73, v76, v173, -v73
    v_mfma_f32_32x32x16_bf16 v[224:239], v[124:127], v[240:243], v[224:239]
    v_cvt_pk_bf16_f32 v80, v64, v65
    v_cvt_pk_bf16_f32 v84, v72, v73
    v_fma_f32 v66, v76, v166, -v66
    v_fma_f32 v67, v76, v167, -v67
    v_fma_f32 v74, v76, v174, -v74
    v_mfma_f32_32x32x16_bf16 v[208:223], v[124:127], v[244:247], v[208:223]
    v_fma_f32 v75, v76, v175, -v75
    v_cvt_pk_bf16_f32 v81, v66, v67
    v_cvt_pk_bf16_f32 v85, v74, v75
    s_xor_b32 s62, s62, 1024
    s_xor_b32 s63, s63, 1024
    s_cmp_lg_u32 s61, 0
    s_cbranch_scc1 L_dloop1
L_dloop_end:
    s_nop 7
    v_cvt_pk_bf16_f32 v128, v176, v177
    v_cvt_pk_bf16_f32 v129, v178, v179
    v_cvt_pk_bf16_f32 v130, v180, v181
    v_cvt_pk_bf16_f32 v131, v182, v183
    v_cvt_pk_bf16_f32 v132, v184, v185
    v_cvt_pk_bf16_f32 v133, v186, v187
    v_cvt_pk_bf16_f32 v134, v188, v189
    v_cvt_pk_bf16_f32 v135, v190, v191
    v_cvt_pk_bf16_f32 v136, v192, v193
    v_cvt_pk_bf16_f32 v137, v194, v195
    v_cvt_pk_bf16_f32 v138, v196, v197
    v_cvt_pk_bf16_f32 v139, v198, v199
    v_cvt_pk_bf16_f32 v140, v200, v201
    v_cvt_pk_bf16_f32 v141, v202, v203
    v_cvt_pk_bf16_f32 v142, v204, v205
    v_cvt_pk_bf16_f32 v143, v206, v207
    v_cvt_pk_bf16_f32 v144, v208, v209
    v_cvt_pk_bf16_f32 v145, v210, v211
    v_cvt_pk_bf16_f32 v146, v212, v213
    v_cvt_pk_bf16_f32 v147, v214, v215
    v_cvt_pk_bf16_f32 v148, v216, v217
    v_cvt_pk_bf16_f32 v149, v218, v219
    v_cvt_pk_bf16_f32 v150, v220, v221
    v_cvt_pk_bf16_f32 v151, v222, v223
    v_cvt_pk_bf16_f32 v152, v224, v225
    v_cvt_pk_bf16_f32 v153, v226, v227
    v_cvt_pk_bf16_f32 v154, v228, v229
    v_cvt_pk_bf16_f32 v155, v230, v231
    v_cvt_pk_bf16_f32 v156, v232, v233
    v_cvt_pk_bf16_f32 v157, v234, v235
    v_cvt_pk_bf16_f32 v158, v236, v237
    v_cvt_pk_bf16_f32 v159, v238, v239
    s_waitcnt lgkmcnt(0)
    s_cmp_lg_u32 s25, 0
    s_cbranch_scc1 L_dc_nospec
    v_mfma_f32_32x32x16_bf16 v[176:191], v[36:39], v[136:139], 0
    v_mfma_f32_32x32x16_bf16 v[192:207], v[44:47], v[136:139], 0
    v_and_b32 v136, v35, v136
    v_and_b32 v137, v35, v137
    v_and_b32 v138, v35, v138
    v_and_b32 v139, v35, v139
    v_mfma_f32_32x32x16_bf16 v[208:223], v[36:39], v[152:155], 0
    v_mfma_f32_32x32x16_bf16 v[224:239], v[44:47], v[152:155], 0
    v_and_b32 v152, v35, v152
    v_and_b32 v153, v35, v153
    v_and_b32 v154, v35, v154
    v_and_b32 v155, v35, v155
    v_mfma_f32_32x32x16_bf16 v[176:191], v[40:43], v[140:143], v[176:191]
    v_mfma_f32_32x32x16_bf16 v[192:207], v[48:51], v[140:143], v[192:207]
    v_and_b32 v140, v35, v140
    v_and_b32 v141, v35, v141
    v_and_b32 v142, v35, v142
    v_and_b32 v143, v35, v143
    v_mfma_f32_32x32x16_bf16 v[208:223], v[40:43], v[156:159], v[208:223]
    v_mfma_f32_32x32x16_bf16 v[224:239], v[48:51], v[156:159], v[224:239]
    v_and_b32 v156, v35, v156
    v_and_b32 v157, v35, v157
    v_and_b32 v158, v35, v158
    v_and_b32 v159, v35, v159
    s_nop 1
    v_cvt_pk_bf16_f32 v96, v176, v192
    v_cvt_pk_bf16_f32 v98, v177, v193
    v_cvt_pk_bf16_f32 v100, v178, v194
    v_cvt_pk_bf16_f32 v102, v179, v195
    v_cvt_pk_bf16_f32 v104, v180, v196
    v_cvt_pk_bf16_f32 v106, v181, v197
    v_cvt_pk_bf16_f32 v108, v182, v198
    v_cvt_pk_bf16_f32 v110, v183, v199
    v_cvt_pk_bf16_f32 v112, v184, v200
    v_cvt_pk_bf16_f32 v114, v185, v201
    v_cvt_pk_bf16_f32 v116, v186, v202
    v_cvt_pk_bf16_f32 v118, v187, v203
    v_cvt_pk_bf16_f32 v120, v188, v204
    v_cvt_pk_bf16_f32 v122, v189, v205
    v_cvt_pk_bf16_f32 v124, v190, v206
    v_cvt_pk_bf16_f32 v126, v191, v207
    v_cvt_pk_bf16_f32 v97, v208, v224
    v_cvt_pk_bf16_f32 v99, v209, v225
    v_cvt_pk_bf16_f32 v101, v210, v226
    v_cvt_pk_bf16_f32 v103, v211, v227
    v_cvt_pk_bf16_f32 v105, v212, v228
    v_cvt_pk_bf16_f32 v107, v213, v229
    v_cvt_pk_bf16_f32 v109, v214, v230
    v_cvt_pk_bf16_f32 v111, v215, v231
    v_cvt_pk_bf16_f32 v113, v216, v232
    v_cvt_pk_bf16_f32 v115, v217, v233
    v_cvt_pk_bf16_f32 v117, v218, v234
    v_cvt_pk_bf16_f32 v119, v219, v235
    v_cvt_pk_bf16_f32 v121, v220, v236
    v_cvt_pk_bf16_f32 v123, v221, v237
    v_cvt_pk_bf16_f32 v125, v222, v238
    v_cvt_pk_bf16_f32 v127, v223, v239
    buffer_store_dwordx2 v[96:97], v29, s[52:55], s64 offen sc1
    buffer_store_dwordx2 v[98:99], v29, s[52:55], s65 offen sc1
    buffer_store_dwordx2 v[100:101], v29, s[52:55], s66 offen sc1
    buffer_store_dwordx2 v[102:103], v29, s[52:55], s67 offen sc1
    buffer_store_dwordx2 v[104:105], v29, s[52:55], s68 offen sc1
    buffer_store_dwordx2 v[106:107], v29, s[52:55], s69 offen sc1
    buffer_store_dwordx2 v[108:109], v29, s[52:55], s70 offen sc1
    buffer_store_dwordx2 v[110:111], v29, s[52:55], s71 offen sc1
    buffer_store_dwordx2 v[112:113], v29, s[52:55], s72 offen sc1
    buffer_store_dwordx2 v[114:115], v29, s[52:55], s73 offen sc1
    buffer_store_dwordx2 v[116:117], v29, s[52:55], s74 offen sc1
    buffer_store_dwordx2 v[118:119], v29, s[52:55], s75 offen sc1
    buffer_store_dwordx2 v[120:121], v29, s[52:55], s76 offen sc1
    buffer_store_dwordx2 v[122:123], v29, s[52:55], s77 offen sc1
    buffer_store_dwordx2 v[124:125], v29, s[52:55], s78 offen sc1
    buffer_store_dwordx2 v[126:127], v29, s[52:55], s79 offen sc1
    s_nop 1
L_dc_nospec:
    s_nop 1
    v_mfma_f32_32x32x16_bf16 v[176:191], v[36:39], v[128:131], 0
    v_mfma_f32_32x32x16_bf16 v[192:207], v[44:47], v[128:131], 0
    v_mfma_f32_32x32x16_bf16 v[176:191], v[40:43], v[132:135], v[176:191]
    v_mfma_f32_32x32x16_bf16 v[192:207], v[48:51], v[132:135], v[192:207]
    v_mfma_f32_32x32x16_bf16 v[176:191], v[52:55], v[136:139], v[176:191]
    v_mfma_f32_32x32x16_bf16 v[192:207], v[36:39], v[136:139], v[192:207]
    v_mfma_f32_32x32x16_bf16 v[176:191], v[56:59], v[140:143], v[176:191]
    v_mfma_f32_32x32x16_bf16 v[192:207], v[40:43], v[140:143], v[192:207]
    v_mfma_f32_32x32x16_bf16 v[208:223], v[36:39], v[144:147], 0
    v_mfma_f32_32x32x16_bf16 v[224:239], v[44:47], v[144:147], 0
    v_mfma_f32_32x32x16_bf16 v[208:223], v[40:43], v[148:151], v[208:223]
    v_mfma_f32_32x32x16_bf16 v[224:239], v[48:51], v[148:151], v[224:239]
    v_mfma_f32_32x32x16_bf16 v[208:223], v[52:55], v[152:155], v[208:223]
    v_mfma_f32_32x32x16_bf16 v[224:239], v[36:39], v[152:155], v[224:239]
    v_mfma_f32_32x32x16_bf16 v[208:223], v[56:59], v[156:159], v[208:223]
    v_mfma_f32_32x32x16_bf16 v[224:239], v[40:43], v[156:159], v[224:239]
    s_nop 3
    v_cvt_pk_bf16_f32 v96, v176, v192
    v_cvt_pk_bf16_f32 v98, v177, v193
    v_cvt_pk_bf16_f32 v100, v178, v194
    v_cvt_pk_bf16_f32 v102, v179, v195
    v_cvt_pk_bf16_f32 v104, v180, v196
    v_cvt_pk_bf16_f32 v106, v181, v197
    v_cvt_pk_bf16_f32 v108, v182, v198
    v_cvt_pk_bf16_f32 v110, v183, v199
    v_cvt_pk_bf16_f32 v112, v184, v200
    v_cvt_pk_bf16_f32 v114, v185, v201
    v_cvt_pk_bf16_f32 v116, v186, v202
    v_cvt_pk_bf16_f32 v118, v187, v203
    v_cvt_pk_bf16_f32 v120, v188, v204
    v_cvt_pk_bf16_f32 v122, v189, v205
    v_cvt_pk_bf16_f32 v124, v190, v206
    v_cvt_pk_bf16_f32 v126, v191, v207
    v_cvt_pk_bf16_f32 v97, v208, v224
    buffer_store_dwordx2 v[96:97], v28, s[52:55], s64 offen sc1
    v_cvt_pk_bf16_f32 v99, v209, v225
    buffer_store_dwordx2 v[98:99], v28, s[52:55], s65 offen sc1
    v_cvt_pk_bf16_f32 v101, v210, v226
    buffer_store_dwordx2 v[100:101], v28, s[52:55], s66 offen sc1
    v_cvt_pk_bf16_f32 v103, v211, v227
    buffer_store_dwordx2 v[102:103], v28, s[52:55], s67 offen sc1
    v_cvt_pk_bf16_f32 v105, v212, v228
    buffer_store_dwordx2 v[104:105], v28, s[52:55], s68 offen sc1
    v_cvt_pk_bf16_f32 v107, v213, v229
    buffer_store_dwordx2 v[106:107], v28, s[52:55], s69 offen sc1
    v_cvt_pk_bf16_f32 v109, v214, v230
    buffer_store_dwordx2 v[108:109], v28, s[52:55], s70 offen sc1
    v_cvt_pk_bf16_f32 v111, v215, v231
    buffer_store_dwordx2 v[110:111], v28, s[52:55], s71 offen sc1
    v_cvt_pk_bf16_f32 v113, v216, v232
    buffer_store_dwordx2 v[112:113], v28, s[52:55], s72 offen sc1
    v_cvt_pk_bf16_f32 v115, v217, v233
    buffer_store_dwordx2 v[114:115], v28, s[52:55], s73 offen sc1
    v_cvt_pk_bf16_f32 v117, v218, v234
    buffer_store_dwordx2 v[116:117], v28, s[52:55], s74 offen sc1
    v_cvt_pk_bf16_f32 v119, v219, v235
    buffer_store_dwordx2 v[118:119], v28, s[52:55], s75 offen sc1
    v_cvt_pk_bf16_f32 v121, v220, v236
    buffer_store_dwordx2 v[120:121], v28, s[52:55], s76 offen sc1
    v_cvt_pk_bf16_f32 v123, v221, v237
    buffer_store_dwordx2 v[122:123], v28, s[52:55], s77 offen sc1
    v_cvt_pk_bf16_f32 v125, v222, v238
    buffer_store_dwordx2 v[124:125], v28, s[52:55], s78 offen sc1
    v_cvt_pk_bf16_f32 v127, v223, v239
    buffer_store_dwordx2 v[126:127], v28, s[52:55], s79 offen sc1
L_dc_end:
    v_mov_b32 v201, s18
    v_mov_b32 v202, s19
    v_and_b32 v203, 1, v0
    v_cmp_eq_u32 vcc, 1, v203
    s_lshl_b32 s64, s6, 7
    s_add_u32 s64, s64, 5799936
    v_cndmask_b32 v201, v201, v202, vcc
    v_add_u32_e64 v201, 1, v201
    v_lshl_add_u32 v200, v0, 15, s64
    v_mov_b32 v202, 163008
    s_call_b64 s[60:61], L_arrive
    s_barrier
    s_endpgm
L_retry0:
    s_sub_u32 s28, s28, 1
    s_cbranch_scc1 L_giveup0
    s_sleep 4
    s_add_u32 m0, s23, 0
    s_call_b64 s[60:61], L_odma0
    s_waitcnt vmcnt(15)
    ds_read_b128 v[66:69], v4 offset:0
    ds_read_b128 v[70:73], v4 offset:64
    ds_read_b128 v[74:77], v5 offset:128
    s_waitcnt lgkmcnt(0)
    v_cmp_eq_u32 vcc, -1, v69
    s_cbranch_vccnz L_retry0
    s_branch L_back0
L_giveup0:
    s_mov_b32 s28, 0
    s_branch L_back0
L_retry1:
    s_sub_u32 s28, s28, 1
    s_cbranch_scc1 L_giveup1
    s_sleep 4
    s_add_u32 m0, s23, 0
    s_call_b64 s[60:61], L_odma0
    s_waitcnt vmcnt(15)
    ds_read_b128 v[70:73], v4 offset:64
    ds_read_b128 v[74:77], v5 offset:128
    ds_read_b128 v[78:81], v4 offset:2592
    s_waitcnt lgkmcnt(0)
    v_cmp_eq_u32 vcc, -1, v73
    s_cbranch_vccnz L_retry1
    s_branch L_back1
L_giveup1:
    s_mov_b32 s28, 0
    s_branch L_back1
L_retry2:
    s_sub_u32 s28, s28, 1
    s_cbranch_scc1 L_giveup2
    s_sleep 4
    s_add_u32 m0, s23, 0
    s_call_b64 s[60:61], L_odma0
    s_waitcnt vmcnt(15)
    ds_read_b128 v[74:77], v5 offset:128
    ds_read_b128 v[78:81], v4 offset:2592
    ds_read_b128 v[82:85], v4 offset:2656
    s_waitcnt lgkmcnt(0)
    v_cmp_eq_u32 vcc, -1, v77
    s_cbranch_vccnz L_retry2
    s_branch L_back2
L_giveup2:
    s_mov_b32 s28, 0
    s_branch L_back2
L_retry3:
    s_sub_u32 s28, s28, 1
    s_cbranch_scc1 L_giveup3
    s_sleep 4
    s_add_u32 m0, s23, 0
    s_call_b64 s[60:61], L_odma0
    s_waitcnt vmcnt(12)
    ds_read_b128 v[78:81], v4 offset:2592
    ds_read_b128 v[82:85], v4 offset:2656
    ds_read_b128 v[86:89], v4 offset:5120
    s_waitcnt lgkmcnt(0)
    v_cmp_eq_u32 vcc, -1, v81
    s_cbranch_vccnz L_retry3
    s_branch L_back3
L_giveup3:
    s_mov_b32 s28, 0
    s_branch L_back3
L_retry4:
    s_sub_u32 s28, s28, 1
    s_cbranch_scc1 L_giveup4
    s_sleep 4
    s_add_u32 m0, s23, 0
    s_call_b64 s[60:61], L_odma0
    s_waitcnt vmcnt(12)
    ds_read_b128 v[82:85], v4 offset:2656
    ds_read_b128 v[86:89], v4 offset:5120
    ds_read_b128 v[66:69], v4 offset:5184
    s_waitcnt lgkmcnt(0)
    v_cmp_eq_u32 vcc, -1, v85
    s_cbranch_vccnz L_retry4
    s_branch L_back4
L_giveup4:
    s_mov_b32 s28, 0
    s_branch L_back4
L_retry5:
    s_sub_u32 s28, s28, 1
    s_cbranch_scc1 L_giveup5
    s_sleep 4
    s_add_u32 m0, s23, 5120
    s_call_b64 s[60:61], L_odma1
    s_waitcnt vmcnt(10)
    ds_read_b128 v[86:89], v4 offset:5120
    ds_read_b128 v[66:69], v4 offset:5184
    ds_read_b128 v[70:73], v5 offset:5248
    s_waitcnt lgkmcnt(0)
    v_cmp_eq_u32 vcc, -1, v89
    s_cbranch_vccnz L_retry5
    s_branch L_back5
L_giveup5:
    s_mov_b32 s28, 0
    s_branch L_back5
L_retry6:
    s_sub_u32 s28, s28, 1
    s_cbranch_scc1 L_giveup6
    s_sleep 4
    s_add_u32 m0, s23, 5120
    s_call_b64 s[60:61], L_odma1
    s_waitcnt vmcnt(10)
    ds_read_b128 v[66:69], v4 offset:5184
    ds_read_b128 v[70:73], v5 offset:5248
    ds_read_b128 v[74:77], v4 offset:7712
    s_waitcnt lgkmcnt(0)
    v_cmp_eq_u32 vcc, -1, v69
    s_cbranch_vccnz L_retry6
    s_branch L_back6
L_giveup6:
    s_mov_b32 s28, 0
    s_branch L_back6
L_retry7:
    s_sub_u32 s28, s28, 1
    s_cbranch_scc1 L_giveup7
    s_sleep 4
    s_add_u32 m0, s23, 5120
    s_call_b64 s[60:61], L_odma1
    s_waitcnt vmcnt(10)
    ds_read_b128 v[70:73], v5 offset:5248
    ds_read_b128 v[74:77], v4 offset:7712
    ds_read_b128 v[78:81], v4 offset:7776
    s_waitcnt lgkmcnt(0)
    v_cmp_eq_u32 vcc, -1, v73
    s_cbranch_vccnz L_retry7
    s_branch L_back7
L_giveup7:
    s_mov_b32 s28, 0
    s_branch L_back7
L_retry8:
    s_sub_u32 s28, s28, 1
    s_cbranch_scc1 L_giveup8
    s_sleep 4
    s_add_u32 m0, s23, 5120
    s_call_b64 s[60:61], L_odma1
    s_waitcnt vmcnt(7)
    ds_read_b128 v[74:77], v4 offset:7712
    ds_read_b128 v[78:81], v4 offset:7776
    ds_read_b128 v[82:85], v4 offset:10240
    s_waitcnt lgkmcnt(0)
    v_cmp_eq_u32 vcc, -1, v77
    s_cbranch_vccnz L_retry8
    s_branch L_back8
L_giveup8:
    s_mov_b32 s28, 0
    s_branch L_back8
L_retry9:
    s_sub_u32 s28, s28, 1
    s_cbranch_scc1 L_giveup9
    s_sleep 4
    s_add_u32 m0, s23, 5120
    s_call_b64 s[60:61], L_odma1
    s_waitcnt vmcnt(7)
    ds_read_b128 v[78:81], v4 offset:7776
    ds_read_b128 v[82:85], v4 offset:10240
    ds_read_b128 v[86:89], v4 offset:10304
    s_waitcnt lgkmcnt(0)
    v_cmp_eq_u32 vcc, -1, v81
    s_cbranch_vccnz L_retry9
    s_branch L_back9
L_giveup9:
    s_mov_b32 s28, 0
    s_branch L_back9
L_retry10:
    s_sub_u32 s28, s28, 1
    s_cbranch_scc1 L_giveup10
    s_sleep 4
    s_add_u32 m0, s23, 10240
    s_call_b64 s[60:61], L_odma2
    s_waitcnt vmcnt(5)
    ds_read_b128 v[82:85], v4 offset:10240
    ds_read_b128 v[86:89], v4 offset:10304
    ds_read_b128 v[66:69], v5 offset:10368
    s_waitcnt lgkmcnt(0)
    v_cmp_eq_u32 vcc, -1, v85
    s_cbranch_vccnz L_retry10
    s_branch L_back10
L_giveup10:
    s_mov_b32 s28, 0
    s_branch L_back10
L_retry11:
    s_sub_u32 s28, s28, 1
    s_cbranch_scc1 L_giveup11
    s_sleep 4
    s_add_u32 m0, s23, 10240
    s_call_b64 s[60:61], L_odma2
    s_waitcnt vmcnt(5)
    ds_read_b128 v[86:89], v4 offset:10304
    ds_read_b128 v[66:69], v5 offset:10368
    ds_read_b128 v[70:73], v4 offset:12832
    s_waitcnt lgkmcnt(0)
    v_cmp_eq_u32 vcc, -1, v89
    s_cbranch_vccnz L_retry11
    s_branch L_back11
L_giveup11:
    s_mov_b32 s28, 0
    s_branch L_back11
L_retry12:
    s_sub_u32 s28, s28, 1
    s_cbranch_scc1 L_giveup12
    s_sleep 4
    s_add_u32 m0, s23, 10240
    s_call_b64 s[60:61], L_odma2
    s_waitcnt vmcnt(5)
    ds_read_b128 v[66:69], v5 offset:10368
    ds_read_b128 v[70:73], v4 offset:12832
    ds_read_b128 v[74:77], v4 offset:12896
    s_waitcnt lgkmcnt(0)
    v_cmp_eq_u32 vcc, -1, v69
    s_cbranch_vccnz L_retry12
    s_branch L_back12
L_giveup12:
    s_mov_b32 s28, 0
    s_branch L_back12
L_retry13:
    s_sub_u32 s28, s28, 1
    s_cbranch_scc1 L_giveup13
    s_sleep 4
    s_add_u32 m0, s23, 10240
    s_call_b64 s[60:61], L_odma2
    s_waitcnt vmcnt(2)
    ds_read_b128 v[70:73], v4 offset:12832
    ds_read_b128 v[74:77], v4 offset:12896
    ds_read_b128 v[78:81], v4 offset:15360
    s_waitcnt lgkmcnt(0)
    v_cmp_eq_u32 vcc, -1, v73
    s_cbranch_vccnz L_retry13
    s_branch L_back13
L_giveup13:
    s_mov_b32 s28, 0
    s_branch L_back13
L_retry14:
    s_sub_u32 s28, s28, 1
    s_cbranch_scc1 L_giveup14
    s_sleep 4
    s_add_u32 m0, s23, 10240
    s_call_b64 s[60:61], L_odma2
    s_waitcnt vmcnt(2)
    ds_read_b128 v[74:77], v4 offset:12896
    ds_read_b128 v[78:81], v4 offset:15360
    ds_read_b128 v[82:85], v4 offset:15424
    s_waitcnt lgkmcnt(0)
    v_cmp_eq_u32 vcc, -1, v77
    s_cbranch_vccnz L_retry14
    s_branch L_back14
L_giveup14:
    s_mov_b32 s28, 0
    s_branch L_back14
L_retry15:
    s_sub_u32 s28, s28, 1
    s_cbranch_scc1 L_giveup15
    s_sleep 4
    s_add_u32 m0, s23, 15360
    s_call_b64 s[60:61], L_odma3
    s_waitcnt vmcnt(0)
    ds_read_b128 v[78:81], v4 offset:15360
    ds_read_b128 v[82:85], v4 offset:15424
    ds_read_b128 v[86:89], v5 offset:15488
    s_waitcnt lgkmcnt(0)
    v_cmp_eq_u32 vcc, -1, v81
    s_cbranch_vccnz L_retry15
    s_branch L_back15
L_giveup15:
    s_mov_b32 s28, 0
    s_branch L_back15
L_retry16:
    s_sub_u32 s28, s28, 1
    s_cbranch_scc1 L_giveup16
    s_sleep 4
    s_add_u32 m0, s23, 15360
    s_call_b64 s[60:61], L_odma3
    s_waitcnt vmcnt(0)
    ds_read_b128 v[82:85], v4 offset:15424
    ds_read_b128 v[86:89], v5 offset:15488
    ds_read_b128 v[66:69], v4 offset:17952
    s_waitcnt lgkmcnt(0)
    v_cmp_eq_u32 vcc, -1, v85
    s_cbranch_vccnz L_retry16
    s_branch L_back16
L_giveup16:
    s_mov_b32 s28, 0
    s_branch L_back16
L_retry17:
    s_sub_u32 s28, s28, 1
    s_cbranch_scc1 L_giveup17
    s_sleep 4
    s_add_u32 m0, s23, 15360
    s_call_b64 s[60:61], L_odma3
    s_waitcnt vmcnt(0)
    ds_read_b128 v[86:89], v5 offset:15488
    ds_read_b128 v[66:69], v4 offset:17952
    ds_read_b128 v[70:73], v4 offset:18016
    s_waitcnt lgkmcnt(0)
    v_cmp_eq_u32 vcc, -1, v89
    s_cbranch_vccnz L_retry17
    s_branch L_back17
L_giveup17:
    s_mov_b32 s28, 0
    s_branch L_back17
L_retry18:
    s_sub_u32 s28, s28, 1
    s_cbranch_scc1 L_giveup18
    s_sleep 4
    s_add_u32 m0, s23, 15360
    s_call_b64 s[60:61], L_odma3
    s_waitcnt vmcnt(0)
    ds_read_b128 v[66:69], v4 offset:17952
    ds_read_b128 v[70:73], v4 offset:18016
    s_waitcnt lgkmcnt(0)
    v_cmp_eq_u32 vcc, -1, v69
    s_cbranch_vccnz L_retry18
    s_branch L_back18
L_giveup18:
    s_mov_b32 s28, 0
    s_branch L_back18
L_retry19:
    s_sub_u32 s28, s28, 1
    s_cbranch_scc1 L_giveup19
    s_sleep 4
    s_add_u32 m0, s23, 15360
    s_call_b64 s[60:61], L_odma3
    s_waitcnt vmcnt(0)
    ds_read_b128 v[70:73], v4 offset:18016
    s_waitcnt lgkmcnt(0)
    v_cmp_eq_u32 vcc, -1, v73
    s_cbranch_vccnz L_retry19
    s_branch L_back19
L_giveup19:
    s_mov_b32 s28, 0
    s_branch L_back19
L_exit:
L_codeend:
    s_endpgm
.section .rodata,"a"
.p2align 6
.amdhsa_kernel gated_mix__spectral_fnet__sliding_local_dilated__prompt_kernel
  .amdhsa_next_free_vgpr 256
  .amdhsa_next_free_sgpr 102
  .amdhsa_accum_offset 256
  .amdhsa_group_segment_fixed_size 0
  .amdhsa_kernarg_size 96
  .amdhsa_user_sgpr_count 2
  .amdhsa_user_sgpr_kernarg_segment_ptr 1
  .amdhsa_system_sgpr_workgroup_id_x 1
.end_amdhsa_kernel
```
